```python
import torch

def _softmax(x, axis=-1):
    return torch.softmax(x, dim=axis)
def _gelu(x):
    return torch.nn.functional.gelu(x, approximate="tanh")
def _silu(x):
    return torch.nn.functional.silu(x)
def _sigmoid(x):
    return torch.sigmoid(x)
def _layernorm(x, axis=-1, eps=1e-5):
    m = x.mean(dim=axis, keepdim=True)
    v = x.var(dim=axis, keepdim=True, unbiased=False)
    return (x - m) / torch.sqrt(v + eps)
def _scatter_add(tgt, idx, src, axis=0):
    return tgt.clone().index_add_(axis, idx, src)
def _segment_sum(src, seg, n):
    out = torch.zeros((n,) + src.shape[1:], dtype=src.dtype)
    return out.index_add_(0, seg, src)
def _pad(x, pw):
    flat = tuple(v for pair in reversed(pw) for v in pair)
    return torch.nn.functional.pad(x, flat)

kernel_name = 'sequential_preLN__sliding_block_cached__mixer_channel_mlp__decode'

def setup_inputs():

    _w = (lambda a: (lambda t: t.to(torch.bfloat16) if t.is_floating_point() else t)(torch.as_tensor(a)))
    def _A_setup():
        B, Sq, D = 4, 1, 448
        Hq, Hkv, Sk, Dh = 16, 8, 4096, 256
        assert Hq % Hkv == 0, (Hq, Hkv)
        return {
            "x": _w((lambda *s: torch.randn(*s, dtype=torch.bfloat16) * 0.05)(B, Sq, D)),
            "k_cache": _w((lambda *s: torch.randn(*s, dtype=torch.bfloat16) * 3.2)(B, Hkv, Sk, Dh)),
            "v_cache": _w((lambda *s: torch.randn(*s, dtype=torch.bfloat16) * 0.4)(B, Hkv, Sk, Dh)),
            "wq": _w((lambda *s: torch.randn(*s, dtype=torch.bfloat16) * 3.2)(D, Hq * Dh) * (D ** -0.5)),
            "wo": _w((lambda *s: torch.randn(*s, dtype=torch.bfloat16) * 0.4)(Hq * Dh, D) * ((Hq * Dh) ** -0.5)),
        }
    _A_in = _A_setup()

    def _B_setup():
        B, S, D, F = 4, 1, 448, 1792
        return {
            "x": _w((lambda *s: torch.randn(*s, dtype=torch.bfloat16) * 0.05)(B, S, D)),
            "w1": _w((lambda *s: torch.randn(*s, dtype=torch.bfloat16) * 3.2)(D, F) * (D ** -0.5)),
            "b1": _w((lambda *s: torch.randn(*s, dtype=torch.bfloat16) * 1.6)(F)),
            "w2": _w((lambda *s: torch.randn(*s, dtype=torch.bfloat16) * 0.1)(F, D) * (F ** -0.5)),
            "b2": _w((lambda *s: torch.randn(*s, dtype=torch.bfloat16) * 0.2)(D)),
        }
    _B_in = _B_setup()

    return {
        "A_x": _A_in["x"],
        "A_k_cache": _A_in["k_cache"],
        "A_v_cache": _A_in["v_cache"],
        "A_wq": _A_in["wq"],
        "A_wo": _A_in["wo"],
        "B_x": _B_in["x"],
        "B_w1": _B_in["w1"],
        "B_b1": _B_in["b1"],
        "B_w2": _B_in["w2"],
        "B_b2": _B_in["b2"],
    }

def reference(A_x, A_k_cache, A_v_cache, A_wq, A_wo, B_x, B_w1, B_b1, B_w2, B_b2):
    def _A_ref(x, k_cache, v_cache, wq, wo):
        B, Sq, D = x.shape
        Hq, Dh = 16, 256
        Hkv, Sk = k_cache.shape[1], k_cache.shape[2]
        W = min(4096, max(256, Sk // 4))
        rep = Hq // Hkv
        q = (lambda x, *d: x.permute(*d))((x @ wq).reshape(B, Sq, Hq, Dh), 0, 2, 1, 3)
        k = (lambda x, n, axis: torch.repeat_interleave(x, n, dim=axis))(k_cache[:, :, Sk - W:, :], rep, axis=1)
        v = (lambda x, n, axis: torch.repeat_interleave(x, n, dim=axis))(v_cache[:, :, Sk - W:, :], rep, axis=1)
        scores = torch.einsum("bhqd,bhkd->bhqk", q, k) * (Dh ** -0.5)
        p = _softmax(scores, axis=-1)
        o = torch.einsum("bhqk,bhkd->bhqd", p, v)
        return (lambda x, *d: x.permute(*d))(o, 0, 2, 1, 3).reshape(B, Sq, Hq * Dh) @ wo

    def _B_ref(x, w1, b1, w2, b2):
        y = _layernorm(x, axis=-1)
        h = _gelu(torch.einsum("bsd,df->bsf", y, w1) + b1)
        return torch.einsum("bsf,fd->bsd", h, w2) + b2

    x = A_x
    h = x + _A_ref(_layernorm(x, axis=-1), A_k_cache, A_v_cache, A_wq, A_wo)
    h2 = h + _B_ref(_layernorm(h, axis=-1), B_w1, B_b1, B_w2, B_b2)
    return h2
```

```asm
; @launch grid=(256,1,1) block=(576,1,1) lds=163840
.amdgcn_target "amdgcn-amd-amdhsa--gfx950"
.text
.globl sequential_preLN__sliding_block_cached__mixer_channel_mlp__decode_kernel
.p2align 8
.type sequential_preLN__sliding_block_cached__mixer_channel_mlp__decode_kernel,@function
sequential_preLN__sliding_block_cached__mixer_channel_mlp__decode_kernel:
    v_cmp_gt_u32 vcc, 64, v0
    s_cbranch_vccnz L_ld
    v_mov_b32 v5, 0
    v_and_b32 v1, 63, v0
    v_lshlrev_b32 v7, 2, v1
    ds_write_b32 v7, v5 offset:30144
    v_and_b32 v7, 60, v7
    ds_write_b32 v7, v5
    s_waitcnt lgkmcnt(0)
    s_barrier
    s_branch L_notld
L_ld:
    s_load_dwordx16 s[8:23], s[0:1], 0
    s_load_dwordx8 s[24:31], s[0:1], 64
    s_load_dwordx2 s[32:33], s[0:1], 96
    v_mov_b32 v1, v0
    s_lshr_b32 s5, s2, 3
    s_cmp_ge_u32 s5, 32
    s_cbranch_scc1 L_end
    s_and_b32 s4, s2, 7
    s_lshl_b32 s53, s4, 3
    s_and_b32 s6, s5, 7
    s_add_u32 s53, s53, s6
    s_lshr_b32 s54, s5, 3
    s_getpc_b64 s[44:45]
L_pc:
    s_lshl_b32 s6, s5, 9
    v_lshl_add_u32 v8, v1, 7, s6
    v_min_u32 v8, L_end-L_pc, v8
    s_mov_b64 exec, 15
    global_load_dword v0, v8, s[44:45]
    s_mov_b64 exec, -1
    v_lshrrev_b32 v12, 3, v1
    v_and_b32 v13, 7, v1
    v_lshlrev_b32 v8, 4, v1
    v_and_b32 v14, 6, v12
    v_xor_b32 v14, v14, v13
    v_lshlrev_b32 v14, 4, v14
    v_lshl_add_u32 v17, v12, 13, v14
    s_mulk_i32 s54, 7168
    s_add_u32 s56, s54, s53
    s_lshl_b32 s56, s56, 7
    s_movk_i32 m0, 21120
    s_movk_i32 s42, 3584
    s_mov_b32 s43, 0x20000
    s_movk_i32 s60, 1024
    s_lshl_b32 s61, s60, 6
    s_movk_i32 s58, 19072
    s_barrier
    s_waitcnt lgkmcnt(0)
    s_mov_b64 s[40:41], s[8:9]
    buffer_load_dwordx4 v8, s[40:43], 0 offen offset:0 lds
    buffer_load_dwordx4 v8, s[40:43], 0 offen offset:1024 lds
    buffer_load_dwordx4 v8, s[40:43], 0 offen offset:2048 lds
    buffer_load_dwordx4 v8, s[40:43], 0 offen offset:3072 lds
    s_movk_i32 m0, 4736
    s_mov_b64 s[40:41], s[14:15]
    s_lshl_b32 s42, s42, 10
L_wql:
    buffer_load_dwordx4 v17, s[40:43], s56 offen nt lds
    s_add_u32 m0, m0, s60
    s_add_u32 s56, s56, s61
    buffer_load_dwordx4 v17, s[40:43], s56 offen nt lds
    s_add_u32 m0, m0, s60
    s_add_u32 s56, s56, s61
    s_cmp_lg_u32 m0, s58
    s_cbranch_scc1 L_wql
    s_and_b32 s6, s5, 3
    s_lshl_b32 s6, s6, 3
    s_add_u32 s55, s4, s6
    s_lshr_b32 s59, s5, 2
    s_bfe_u32 s65, s5, 0x20002
    s_lshr_b32 s66, s5, 4
    s_mul_i32 s69, s59, 5
    s_add_u32 s69, s69, s2
    s_and_b32 s69, s69, 15
    v_mov_b32 v5, 0
    v_xor_b32 v9, v12, v13
    v_lshlrev_b32 v9, 4, v9
    v_lshl_add_u32 v9, v12, 9, v9
    s_lshl_b32 s57, s55, 21
    s_add_u32 s57, s57, 0x180000
    s_lshl_b32 s6, s59, 16
    s_add_u32 s6, s6, s57
    s_lshl_b32 s56, s69, 12
    s_mov_b32 m0, 98304
    s_add_u32 s40, s10, s6
    s_addc_u32 s41, s11, 0
    s_mov_b32 s42, 0x10000
    v_lshl_add_u32 v10, v12, 9, v14
    s_lshl_b32 s61, s66, 18
    s_add_u32 s61, s61, s57
    s_lshl_b32 s6, s65, 7
    s_add_u32 s61, s61, s6
    buffer_load_dwordx4 v9, s[40:43], s56 offen nt lds
    s_add_u32 m0, m0, s60
    s_addk_i32 s56, 128
    buffer_load_dwordx4 v9, s[40:43], s56 offen nt lds
    s_add_u32 m0, m0, s60
    s_addk_i32 s56, 128
    v_mov_b32 v7, 0
    s_waitcnt vmcnt(18)
    v_add_u32 v7, 2, v7
    ds_write_b32 v5, v7 offset:0
    buffer_load_dwordx4 v9, s[40:43], s56 offen nt lds
    s_add_u32 m0, m0, s60
    s_addk_i32 s56, 128
    buffer_load_dwordx4 v9, s[40:43], s56 offen nt lds
    s_add_u32 m0, m0, s60
    s_addk_i32 s56, 3712
    s_and_b32 s56, s56, 0xffff
    s_mov_b32 s58, 15
L_seg_1:
    s_waitcnt vmcnt(18)
    v_add_u32 v7, 2, v7
    ds_write_b32 v5, v7 offset:0
    buffer_load_dwordx4 v9, s[40:43], s56 offen nt lds
    s_add_u32 m0, m0, s60
    s_addk_i32 s56, 128
    buffer_load_dwordx4 v9, s[40:43], s56 offen nt lds
    s_add_u32 m0, m0, s60
    s_addk_i32 s56, 128
    s_waitcnt vmcnt(18)
    v_add_u32 v7, 2, v7
    ds_write_b32 v5, v7 offset:0
    buffer_load_dwordx4 v9, s[40:43], s56 offen nt lds
    s_add_u32 m0, m0, s60
    s_addk_i32 s56, 128
    buffer_load_dwordx4 v9, s[40:43], s56 offen nt lds
    s_add_u32 m0, m0, s60
    s_addk_i32 s56, 3712
    s_and_b32 s56, s56, 0xffff
    s_sub_u32 s58, s58, 1
    s_cmp_lg_u32 s58, 0
    s_cbranch_scc1 L_seg_1
    s_mov_b64 s[40:41], s[12:13]
    s_mov_b32 s42, 0x4000000
    s_mov_b32 s56, s61
    s_mov_b32 m0, 32768
    s_and_b32 s68, s5, 7
    s_lshr_b32 s70, s5, 4
    s_add_u32 s6, s5, 8
    s_and_b32 s6, s6, 0x17
    s_cmp_lt_u32 s6, 7
    s_cbranch_scc1 L_ld_wo
    s_sub_u32 s6, s5, 8
    s_cmp_ge_u32 s6, 16
    s_cbranch_scc1 L_ld_idle
    s_and_b32 s70, s6, 3
    s_lshr_b32 s6, s6, 2
    s_lshl_b32 s68, s6, 3
    s_add_u32 s68, s68, s4
    s_cmp_ge_u32 s68, 28
    s_cbranch_scc1 L_ld_idle
    s_mov_b32 s58, 16
L_seg_2:
    s_waitcnt vmcnt(18)
    v_add_u32 v7, 2, v7
    ds_write_b32 v5, v7 offset:0
    buffer_load_dwordx4 v10, s[40:43], s56 offen nt lds
    s_add_u32 m0, m0, s60
    s_addk_i32 s56, 4096
    buffer_load_dwordx4 v10, s[40:43], s56 offen nt lds
    s_add_u32 m0, m0, s60
    s_addk_i32 s56, 4096
    s_waitcnt vmcnt(18)
    v_add_u32 v7, 2, v7
    ds_write_b32 v5, v7 offset:0
    buffer_load_dwordx4 v10, s[40:43], s56 offen nt lds
    s_add_u32 m0, m0, s60
    s_addk_i32 s56, 4096
    buffer_load_dwordx4 v10, s[40:43], s56 offen nt lds
    s_add_u32 m0, m0, s60
    s_addk_i32 s56, 4096
    s_sub_u32 s58, s58, 1
    s_cmp_lg_u32 s58, 0
    s_cbranch_scc1 L_seg_2
    s_mov_b64 s[40:41], s[20:21]
    s_mov_b32 s42, 1605632
    v_mul_u32_u24 v8, 3584, v12
    v_add_u32 v8, v8, v14
    s_mul_i32 s56, s70, 401408
    s_lshl_b32 s6, s68, 7
    s_add_u32 s56, s56, s6
    s_mul_i32 s6, s70, 14336
    s_add_u32 m0, s6, 98304
    s_mov_b32 s7, 4194304
L_spin_3:
    ds_read_b32 v11, v5 offset:24
    s_sub_u32 s7, s7, 1
    s_cbranch_scc1 L_end
    s_waitcnt lgkmcnt(0)
    v_cmp_gt_u32 vcc, 4, v11
    s_cbranch_vccnz L_spin_3
    s_waitcnt vmcnt(18)
    v_add_u32 v7, 2, v7
    ds_write_b32 v5, v7 offset:0
    s_waitcnt vmcnt(16)
    v_add_u32 v7, 2, v7
    ds_write_b32 v5, v7 offset:0
    s_waitcnt vmcnt(14)
    v_add_u32 v7, 2, v7
    ds_write_b32 v5, v7 offset:0
    s_waitcnt vmcnt(12)
    v_add_u32 v7, 2, v7
    ds_write_b32 v5, v7 offset:0
    v_subrev_u32 v7, 8, v7
    s_mov_b32 s58, 7
L_seg_4:
    s_waitcnt vmcnt(18)
    v_add_u32 v7, 2, v7
    ds_write_b32 v5, v7 offset:0
    buffer_load_dwordx4 v8, s[40:43], s56 offen  lds
    s_add_u32 m0, m0, s60
    s_addk_i32 s56, 28672
    buffer_load_dwordx4 v8, s[40:43], s56 offen  lds
    s_add_u32 m0, m0, s60
    s_addk_i32 s56, 28672
    s_sub_u32 s58, s58, 1
    s_cmp_lg_u32 s58, 0
    s_cbranch_scc1 L_seg_4
    s_waitcnt vmcnt(18)
    v_add_u32 v7, 2, v7
    ds_write_b32 v5, v7 offset:0
    s_waitcnt vmcnt(16)
    v_add_u32 v7, 2, v7
    ds_write_b32 v5, v7 offset:0
    s_waitcnt vmcnt(14)
    v_add_u32 v7, 2, v7
    ds_write_b32 v5, v7 offset:0
    s_mov_b32 s58, 3
L_w1q:
    s_cmp_lg_u32 m0, 155648
    s_cbranch_scc1 L_w1n
    s_mov_b32 m0, 98304
    s_lshl_b32 s56, s68, 7
L_w1n:
    s_waitcnt vmcnt(21)
    buffer_load_dwordx4 v8, s[40:43], s56 offen nt lds
    s_add_u32 m0, m0, s60
    s_addk_i32 s56, 28672
    buffer_load_dwordx4 v8, s[40:43], s56 offen nt lds
    s_add_u32 m0, m0, s60
    s_addk_i32 s56, 28672
    buffer_load_dwordx4 v8, s[40:43], s56 offen nt lds
    s_add_u32 m0, m0, s60
    s_addk_i32 s56, 28672
    buffer_load_dwordx4 v8, s[40:43], s56 offen nt lds
    s_add_u32 m0, m0, s60
    s_addk_i32 s56, 28672
    buffer_load_dwordx4 v8, s[40:43], s56 offen nt lds
    s_add_u32 m0, m0, s60
    s_addk_i32 s56, 28672
    buffer_load_dwordx4 v8, s[40:43], s56 offen nt lds
    s_add_u32 m0, m0, s60
    s_addk_i32 s56, 28672
    buffer_load_dwordx4 v8, s[40:43], s56 offen nt lds
    s_add_u32 m0, m0, s60
    s_addk_i32 s56, 28672
    s_waitcnt vmcnt(21)
    buffer_load_dwordx4 v8, s[40:43], s56 offen nt lds
    s_add_u32 m0, m0, s60
    s_addk_i32 s56, 28672
    buffer_load_dwordx4 v8, s[40:43], s56 offen nt lds
    s_add_u32 m0, m0, s60
    s_addk_i32 s56, 28672
    buffer_load_dwordx4 v8, s[40:43], s56 offen nt lds
    s_add_u32 m0, m0, s60
    s_addk_i32 s56, 28672
    buffer_load_dwordx4 v8, s[40:43], s56 offen nt lds
    s_add_u32 m0, m0, s60
    s_addk_i32 s56, 28672
    buffer_load_dwordx4 v8, s[40:43], s56 offen nt lds
    s_add_u32 m0, m0, s60
    s_addk_i32 s56, 28672
    buffer_load_dwordx4 v8, s[40:43], s56 offen nt lds
    s_add_u32 m0, m0, s60
    s_addk_i32 s56, 28672
    buffer_load_dwordx4 v8, s[40:43], s56 offen nt lds
    s_add_u32 m0, m0, s60
    s_addk_i32 s56, 28672
    s_sub_u32 s58, s58, 1
    s_cmp_lg_u32 s58, 0
    s_cbranch_scc1 L_w1q
    v_mov_b32 v7, 0xd4
    s_waitcnt vmcnt(0)
    ds_write_b32 v5, v7 offset:0
    s_branch L_fin
L_ld_wo:
    s_mov_b32 s58, 16
L_seg_5:
    s_waitcnt vmcnt(18)
    v_add_u32 v7, 2, v7
    ds_write_b32 v5, v7 offset:0
    buffer_load_dwordx4 v10, s[40:43], s56 offen nt lds
    s_add_u32 m0, m0, s60
    s_addk_i32 s56, 4096
    buffer_load_dwordx4 v10, s[40:43], s56 offen nt lds
    s_add_u32 m0, m0, s60
    s_addk_i32 s56, 4096
    s_waitcnt vmcnt(18)
    v_add_u32 v7, 2, v7
    ds_write_b32 v5, v7 offset:0
    buffer_load_dwordx4 v10, s[40:43], s56 offen nt lds
    s_add_u32 m0, m0, s60
    s_addk_i32 s56, 4096
    buffer_load_dwordx4 v10, s[40:43], s56 offen nt lds
    s_add_u32 m0, m0, s60
    s_addk_i32 s56, 4096
    s_sub_u32 s58, s58, 1
    s_cmp_lg_u32 s58, 0
    s_cbranch_scc1 L_seg_5
    s_mov_b64 s[40:41], s[16:17]
    s_mov_b32 s42, 3670016
    v_mul_u32_u24 v8, 896, v12
    v_add_u32 v8, v8, v14
    s_mul_i32 s56, s4, 458752
    s_lshl_b32 s6, s68, 7
    s_add_u32 s56, s56, s6
    s_mul_i32 s6, s70, 114688
    s_add_u32 s56, s56, s6
    s_mov_b32 m0, 98304
    v_add_u32 v7, -8, v7
    s_mov_b32 s7, 4194304
L_spin_6:
    ds_read_b32 v11, v5 offset:24
    s_sub_u32 s7, s7, 1
    s_cbranch_scc1 L_end
    s_waitcnt lgkmcnt(0)
    v_cmp_gt_u32 vcc, 4, v11
    s_cbranch_vccnz L_spin_6
    s_mov_b32 s58, 4
L_seg_7:
    s_waitcnt vmcnt(26)
    v_add_u32 v7, 2, v7
    ds_write_b32 v5, v7 offset:0
    buffer_load_dwordx4 v8, s[40:43], s56 offen nt lds
    s_add_u32 m0, m0, s60
    s_addk_i32 s56, 7168
    buffer_load_dwordx4 v8, s[40:43], s56 offen nt lds
    s_add_u32 m0, m0, s60
    s_addk_i32 s56, 7168
    s_waitcnt vmcnt(26)
    v_add_u32 v7, 2, v7
    ds_write_b32 v5, v7 offset:0
    buffer_load_dwordx4 v8, s[40:43], s56 offen nt lds
    s_add_u32 m0, m0, s60
    s_addk_i32 s56, 7168
    buffer_load_dwordx4 v8, s[40:43], s56 offen nt lds
    s_add_u32 m0, m0, s60
    s_addk_i32 s56, 7168
    s_sub_u32 s58, s58, 1
    s_cmp_lg_u32 s58, 0
    s_cbranch_scc1 L_seg_7
    s_add_u32 s56, s56, 114688
    s_mov_b32 s58, 4
L_seg_8:
    s_waitcnt vmcnt(26)
    v_add_u32 v7, 2, v7
    ds_write_b32 v5, v7 offset:0
    buffer_load_dwordx4 v8, s[40:43], s56 offen nt lds
    s_add_u32 m0, m0, s60
    s_addk_i32 s56, 7168
    buffer_load_dwordx4 v8, s[40:43], s56 offen nt lds
    s_add_u32 m0, m0, s60
    s_addk_i32 s56, 7168
    s_waitcnt vmcnt(26)
    v_add_u32 v7, 2, v7
    ds_write_b32 v5, v7 offset:0
    buffer_load_dwordx4 v8, s[40:43], s56 offen nt lds
    s_add_u32 m0, m0, s60
    s_addk_i32 s56, 7168
    buffer_load_dwordx4 v8, s[40:43], s56 offen nt lds
    s_add_u32 m0, m0, s60
    s_addk_i32 s56, 7168
    s_sub_u32 s58, s58, 1
    s_cmp_lg_u32 s58, 0
    s_cbranch_scc1 L_seg_8
    s_waitcnt vmcnt(26)
    v_add_u32 v7, 2, v7
    ds_write_b32 v5, v7 offset:0
    s_waitcnt vmcnt(24)
    v_add_u32 v7, 2, v7
    ds_write_b32 v5, v7 offset:0
    s_waitcnt vmcnt(22)
    v_add_u32 v7, 2, v7
    ds_write_b32 v5, v7 offset:0
    s_waitcnt vmcnt(20)
    v_add_u32 v7, 2, v7
    ds_write_b32 v5, v7 offset:0
    s_waitcnt vmcnt(18)
    v_add_u32 v7, 2, v7
    ds_write_b32 v5, v7 offset:0
    s_waitcnt vmcnt(16)
    v_add_u32 v7, 2, v7
    ds_write_b32 v5, v7 offset:0
    s_waitcnt vmcnt(14)
    v_add_u32 v7, 2, v7
    ds_write_b32 v5, v7 offset:0
    s_waitcnt vmcnt(12)
    v_add_u32 v7, 2, v7
    ds_write_b32 v5, v7 offset:0
    s_waitcnt vmcnt(10)
    v_add_u32 v7, 2, v7
    ds_write_b32 v5, v7 offset:0
    s_waitcnt vmcnt(8)
    v_add_u32 v7, 2, v7
    ds_write_b32 v5, v7 offset:0
    s_waitcnt vmcnt(6)
    v_add_u32 v7, 2, v7
    ds_write_b32 v5, v7 offset:0
    s_waitcnt vmcnt(4)
    v_add_u32 v7, 2, v7
    ds_write_b32 v5, v7 offset:0
    s_waitcnt vmcnt(2)
    v_add_u32 v7, 2, v7
    ds_write_b32 v5, v7 offset:0
    s_waitcnt vmcnt(0)
    v_add_u32 v7, 2, v7
    ds_write_b32 v5, v7 offset:0
    s_branch L_fin
L_ld_idle:
    s_mov_b32 s58, 16
L_seg_9:
    s_waitcnt vmcnt(18)
    v_add_u32 v7, 2, v7
    ds_write_b32 v5, v7 offset:0
    buffer_load_dwordx4 v10, s[40:43], s56 offen nt lds
    s_add_u32 m0, m0, s60
    s_addk_i32 s56, 4096
    buffer_load_dwordx4 v10, s[40:43], s56 offen nt lds
    s_add_u32 m0, m0, s60
    s_addk_i32 s56, 4096
    s_waitcnt vmcnt(18)
    v_add_u32 v7, 2, v7
    ds_write_b32 v5, v7 offset:0
    buffer_load_dwordx4 v10, s[40:43], s56 offen nt lds
    s_add_u32 m0, m0, s60
    s_addk_i32 s56, 4096
    buffer_load_dwordx4 v10, s[40:43], s56 offen nt lds
    s_add_u32 m0, m0, s60
    s_addk_i32 s56, 4096
    s_sub_u32 s58, s58, 1
    s_cmp_lg_u32 s58, 0
    s_cbranch_scc1 L_seg_9
    s_waitcnt vmcnt(18)
    v_add_u32 v7, 2, v7
    ds_write_b32 v5, v7 offset:0
    s_waitcnt vmcnt(16)
    v_add_u32 v7, 2, v7
    ds_write_b32 v5, v7 offset:0
    s_waitcnt vmcnt(14)
    v_add_u32 v7, 2, v7
    ds_write_b32 v5, v7 offset:0
    s_waitcnt vmcnt(12)
    v_add_u32 v7, 2, v7
    ds_write_b32 v5, v7 offset:0
    s_waitcnt vmcnt(10)
    v_add_u32 v7, 2, v7
    ds_write_b32 v5, v7 offset:0
    s_waitcnt vmcnt(8)
    v_add_u32 v7, 2, v7
    ds_write_b32 v5, v7 offset:0
    s_waitcnt vmcnt(6)
    v_add_u32 v7, 2, v7
    ds_write_b32 v5, v7 offset:0
    s_waitcnt vmcnt(4)
    v_add_u32 v7, 2, v7
    ds_write_b32 v5, v7 offset:0
    s_waitcnt vmcnt(2)
    v_add_u32 v7, 2, v7
    ds_write_b32 v5, v7 offset:0
    s_waitcnt vmcnt(0)
    v_add_u32 v7, 2, v7
    ds_write_b32 v5, v7 offset:0
    s_branch L_fin
L_notld:
    s_load_dwordx16 s[8:23], s[0:1], 0
    s_load_dwordx8 s[24:31], s[0:1], 64
    s_load_dwordx2 s[32:33], s[0:1], 96
    v_readfirstlane_b32 s3, v0
    s_lshr_b32 s5, s2, 3
    s_cmp_ge_u32 s5, 32
    s_cbranch_scc1 L_end
    s_and_b32 s4, s2, 7
    s_lshl_b32 s53, s4, 3
    s_and_b32 s6, s5, 7
    s_add_u32 s53, s53, s6
    s_lshr_b32 s54, s5, 3
    s_lshr_b32 s3, s3, 6
    s_sub_u32 s3, s3, 1
    s_waitcnt lgkmcnt(0)
    s_load_dword s34, s[32:33], 0
    s_and_b32 s6, s5, 3
    s_lshl_b32 s6, s6, 3
    s_add_u32 s55, s4, s6
    s_lshr_b32 s59, s5, 2
    s_bfe_u32 s65, s5, 0x20002
    s_lshr_b32 s66, s5, 4
    s_mul_i32 s69, s59, 5
    s_add_u32 s69, s69, s2
    s_and_b32 s69, s69, 15
    v_mov_b32 v5, 0
    v_and_b32 v2, 15, v1
    v_lshrrev_b32 v3, 4, v1
    v_mov_b32 v4, 0xff
    v_mov_b32 v6, 1
    s_mov_b32 s36, s32
    s_mov_b32 s37, s33
    s_mov_b32 s38, 0x10000000
    s_mov_b32 s39, 0x20000
    s_cmp_ge_u32 s3, 4
    s_cbranch_scc1 L_comm
    v_mov_b32 v30, 0x3b124925
    v_mov_b32 v31, 0xffff0000
    v_lshrrev_b32 v44, 2, v2
    v_lshl_add_u32 v44, v3, 2, v44
    v_bfe_u32 v45, v44, 1, 2
    v_lshlrev_b32 v44, 7, v44
    v_and_b32 v41, 3, v2
    v_lshl_add_u32 v44, v41, 3, v44
    s_lshl_b32 s6, s3, 1
    s_and_b32 s6, s6, 3
    v_xor_b32 v40, s6, v45
    v_lshl_add_u32 v40, v40, 5, v44
    v_xor_b32 v43, 32, v40
    v_lshlrev_b32 v42, 14, v41
    v_mul_u32_u24 v41, 896, v41
    v_lshl_add_u32 v41, v3, 3, v41
    s_mul_i32 s6, s54, 224
    v_add_u32 v41, s6, v41
    v_bfe_u32 v46, v2, 2, 1
    v_lshl_add_u32 v42, v46, 6, v42
    v_lshl_add_u32 v42, v3, 4, v42
    v_cmp_ne_u32 s[46:47], 0, v46
    s_lshl_b32 s58, s54, 16
    s_lshl_b32 s6, s53, 8
    s_add_u32 s58, s58, s6
    s_lshl_b32 s6, s3, 7
    s_add_u32 s58, s58, s6
    s_add_u32 s58, s58, 344064
    s_mul_i32 s6, s3, 896
    v_lshl_add_u32 v16, v1, 4, s6
    s_mov_b32 s7, 4194304
L_spin_10:
    ds_read_b32 v7, v5 offset:0
    ds_read_b128 v[32:35], v16 offset:21120
    s_sub_u32 s7, s7, 1
    s_cbranch_scc1 L_end
    s_waitcnt lgkmcnt(0)
    v_cmp_gt_u32 vcc, 4, v7
    s_cbranch_vccnz L_spin_10
    v_lshlrev_b32 v48, 16, v32
    v_and_b32 v49, v31, v32
    v_lshlrev_b32 v50, 16, v33
    v_and_b32 v51, v31, v33
    v_lshlrev_b32 v52, 16, v34
    v_and_b32 v53, v31, v34
    v_lshlrev_b32 v54, 16, v35
    v_and_b32 v55, v31, v35
    v_readfirstlane_b32 s60, v48
    v_mov_b32 v26, 0
    v_mov_b32 v27, 0
    s_mov_b32 s61, s60
    s_mov_b32 exec_hi, 0xffffff
    v_pk_add_f32 v[18:19], v[48:49], s[60:61] neg_lo:[0,1] neg_hi:[0,1]
    v_pk_add_f32 v[20:21], v[50:51], s[60:61] neg_lo:[0,1] neg_hi:[0,1]
    v_pk_add_f32 v[22:23], v[52:53], s[60:61] neg_lo:[0,1] neg_hi:[0,1]
    v_pk_add_f32 v[24:25], v[54:55], s[60:61] neg_lo:[0,1] neg_hi:[0,1]
    v_pk_add_f32 v[28:29], v[18:19], v[20:21]
    v_pk_mul_f32 v[8:9], v[18:19], v[18:19]
    v_pk_add_f32 v[10:11], v[22:23], v[24:25]
    v_pk_fma_f32 v[8:9], v[20:21], v[20:21], v[8:9]
    v_pk_add_f32 v[28:29], v[28:29], v[10:11]
    v_pk_fma_f32 v[8:9], v[22:23], v[22:23], v[8:9]
    v_add_f32 v26, v28, v29
    v_pk_fma_f32 v[8:9], v[24:25], v[24:25], v[8:9]
    v_add_f32 v27, v8, v9
    s_mov_b64 exec, -1
    v_add_f32_dpp v26, v26, v26 row_shr:1 row_mask:0xf bank_mask:0xf
    v_add_f32_dpp v27, v27, v27 row_shr:1 row_mask:0xf bank_mask:0xf
    s_nop 0
    v_add_f32_dpp v26, v26, v26 row_shr:2 row_mask:0xf bank_mask:0xf
    v_add_f32_dpp v27, v27, v27 row_shr:2 row_mask:0xf bank_mask:0xf
    s_nop 0
    v_add_f32_dpp v26, v26, v26 row_shr:4 row_mask:0xf bank_mask:0xf
    v_add_f32_dpp v27, v27, v27 row_shr:4 row_mask:0xf bank_mask:0xf
    s_nop 0
    v_add_f32_dpp v26, v26, v26 row_shr:8 row_mask:0xf bank_mask:0xf
    v_add_f32_dpp v27, v27, v27 row_shr:8 row_mask:0xf bank_mask:0xf
    s_nop 0
    v_add_f32_dpp v26, v26, v26 row_bcast:15 row_mask:0xa bank_mask:0xf
    v_add_f32_dpp v27, v27, v27 row_bcast:15 row_mask:0xa bank_mask:0xf
    s_nop 0
    v_add_f32_dpp v26, v26, v26 row_bcast:31 row_mask:0xc bank_mask:0xf
    v_add_f32_dpp v27, v27, v27 row_bcast:31 row_mask:0xc bank_mask:0xf
    v_readlane_b32 s62, v26, 63
    v_readlane_b32 s63, v27, 63
    s_nop 0
    v_mul_f32 v26, s62, v30
    v_mul_f32 v27, s63, v30
    v_fma_f32 v27, -v26, v26, v27
    v_add_f32 v26, s60, v26
    v_max_f32 v27, 0, v27
    v_cvt_pk_bf16_f32 v27, v26, v27
    v_lshlrev_b32 v28, 16, v27
    v_and_b32 v27, v31, v27
    v_add_f32 v27, 0x3727c5ac, v27
    v_pk_add_f32 v[18:19], v[48:49], v[28:29] op_sel_hi:[1,0] neg_lo:[0,1] neg_hi:[0,1]
    v_cvt_pk_bf16_f32 v27, v27, v27
    v_pk_add_f32 v[20:21], v[50:51], v[28:29] op_sel_hi:[1,0] neg_lo:[0,1] neg_hi:[0,1]
    v_lshlrev_b32 v27, 16, v27
    v_pk_add_f32 v[22:23], v[52:53], v[28:29] op_sel_hi:[1,0] neg_lo:[0,1] neg_hi:[0,1]
    v_sqrt_f32 v27, v27
    v_pk_add_f32 v[24:25], v[54:55], v[28:29] op_sel_hi:[1,0] neg_lo:[0,1] neg_hi:[0,1]
    v_cvt_pk_bf16_f32 v8, v18, v19
    v_cvt_pk_bf16_f32 v27, v27, v27
    v_cvt_pk_bf16_f32 v9, v20, v21
    v_lshlrev_b32 v27, 16, v27
    v_cvt_pk_bf16_f32 v10, v22, v23
    v_rcp_f32 v28, v27
    v_cvt_pk_bf16_f32 v11, v24, v25
    v_lshlrev_b32 v18, 16, v8
    v_and_b32 v19, v31, v8
    v_lshlrev_b32 v20, 16, v9
    v_and_b32 v21, v31, v9
    v_lshlrev_b32 v22, 16, v10
    v_and_b32 v23, v31, v10
    v_lshlrev_b32 v24, 16, v11
    v_and_b32 v25, v31, v11
    v_pk_mul_f32 v[18:19], v[18:19], v[28:29] op_sel_hi:[1,0]
    v_pk_mul_f32 v[20:21], v[20:21], v[28:29] op_sel_hi:[1,0]
    v_pk_mul_f32 v[22:23], v[22:23], v[28:29] op_sel_hi:[1,0]
    v_pk_mul_f32 v[24:25], v[24:25], v[28:29] op_sel_hi:[1,0]
    v_cvt_pk_bf16_f32 v8, v18, v19
    v_cvt_pk_bf16_f32 v9, v20, v21
    v_cvt_pk_bf16_f32 v10, v22, v23
    v_cvt_pk_bf16_f32 v11, v24, v25
    s_mov_b32 exec_hi, 0xffffff
    ds_write_b128 v16, v[8:11] offset:64
    s_mov_b64 exec, 1
    ds_add_u32 v5, v6 offset:4
    s_mov_b64 exec, -1
    s_add_u32 s34, s34, 0x9E3779B9
    s_and_b32 s48, s34, 0xff
    s_bfe_u32 s49, s34, 0x80008
    s_bfe_u32 s50, s34, 0x80010
    s_lshr_b32 s51, s34, 24
    s_cmp_ge_u32 s3, 2
    s_cbranch_scc1 L_qdone
    s_mov_b32 s7, 4194304
L_spin_11:
    ds_read_b64 v[20:21], v5
    s_sub_u32 s7, s7, 1
    s_cbranch_scc1 L_end
    s_waitcnt lgkmcnt(0)
    v_cmp_gt_u32 vcc, 18, v20
    v_cmp_gt_u32 s[62:63], 6, v21
    s_or_b64 vcc, vcc, s[62:63]
    s_cbranch_vccnz L_spin_11
    ds_read_b64 v[76:77], v41 offset:64
    ds_read_b64_tr_b16 v[48:49], v40 offset:4736
    ds_read_b64_tr_b16 v[62:63], v43 offset:4736
    ds_read_b64 v[78:79], v41 offset:96
    ds_read_b64_tr_b16 v[50:51], v40 offset:6784
    ds_read_b64_tr_b16 v[64:65], v43 offset:6784
    ds_read_b64 v[80:81], v41 offset:128
    ds_read_b64_tr_b16 v[52:53], v40 offset:8832
    ds_read_b64_tr_b16 v[66:67], v43 offset:8832
    ds_read_b64 v[82:83], v41 offset:160
    ds_read_b64_tr_b16 v[54:55], v40 offset:10880
    ds_read_b64_tr_b16 v[68:69], v43 offset:10880
    s_waitcnt lgkmcnt(10)
    v_mfma_f32_16x16x16_bf16 v[20:23], v[48:49], v[76:77], 0
    ds_read_b64 v[84:85], v41 offset:192
    ds_read_b64_tr_b16 v[56:57], v40 offset:12928
    s_waitcnt lgkmcnt(11)
    v_mfma_f32_16x16x16_bf16 v[24:27], v[62:63], v[76:77], 0
    ds_read_b64_tr_b16 v[70:71], v43 offset:12928
    ds_read_b64 v[86:87], v41 offset:224
    s_waitcnt lgkmcnt(11)
    v_mfma_f32_16x16x16_bf16 v[20:23], v[50:51], v[78:79], v[20:23]
    ds_read_b64_tr_b16 v[58:59], v40 offset:14976
    ds_read_b64_tr_b16 v[72:73], v43 offset:14976
    s_waitcnt lgkmcnt(12)
    v_mfma_f32_16x16x16_bf16 v[24:27], v[64:65], v[78:79], v[24:27]
    ds_read_b64 v[88:89], v41 offset:256
    ds_read_b64_tr_b16 v[60:61], v40 offset:17024
    s_waitcnt lgkmcnt(12)
    v_mfma_f32_16x16x16_bf16 v[20:23], v[52:53], v[80:81], v[20:23]
    ds_read_b64_tr_b16 v[74:75], v43 offset:17024
    s_waitcnt lgkmcnt(12)
    v_mfma_f32_16x16x16_bf16 v[24:27], v[66:67], v[80:81], v[24:27]
    s_waitcnt lgkmcnt(10)
    v_mfma_f32_16x16x16_bf16 v[20:23], v[54:55], v[82:83], v[20:23]
    s_waitcnt lgkmcnt(9)
    v_mfma_f32_16x16x16_bf16 v[24:27], v[68:69], v[82:83], v[24:27]
    s_waitcnt lgkmcnt(7)
    v_mfma_f32_16x16x16_bf16 v[20:23], v[56:57], v[84:85], v[20:23]
    s_waitcnt lgkmcnt(6)
    v_mfma_f32_16x16x16_bf16 v[24:27], v[70:71], v[84:85], v[24:27]
    s_waitcnt lgkmcnt(4)
    v_mfma_f32_16x16x16_bf16 v[20:23], v[58:59], v[86:87], v[20:23]
    s_waitcnt lgkmcnt(3)
    v_mfma_f32_16x16x16_bf16 v[24:27], v[72:73], v[86:87], v[24:27]
    s_waitcnt lgkmcnt(1)
    v_mfma_f32_16x16x16_bf16 v[20:23], v[60:61], v[88:89], v[20:23]
    s_waitcnt lgkmcnt(0)
    v_mfma_f32_16x16x16_bf16 v[24:27], v[74:75], v[88:89], v[24:27]
    s_nop 7
    v_cndmask_b32 v20, v20, v24, s[46:47]
    v_cndmask_b32 v21, v21, v25, s[46:47]
    v_cndmask_b32 v22, v22, v26, s[46:47]
    v_cndmask_b32 v23, v23, v27, s[46:47]
    v_add_u32 v20, 0x80, v20
    v_add_u32 v21, 0x80, v21
    v_add_u32 v22, 0x80, v22
    v_add_u32 v23, 0x80, v23
    v_bfi_b32 v32, v4, s48, v20
    v_bfi_b32 v33, v4, s49, v21
    v_bfi_b32 v34, v4, s50, v22
    v_bfi_b32 v35, v4, s51, v23
    s_mov_b32 exec_lo, 0xff00ff
    s_mov_b32 exec_hi, 0xff00ff
    buffer_store_dwordx4 v[32:35], v42, s[36:39], s58 offen
    s_mov_b64 exec, -1
L_qdone:
    s_call_b64 s[44:45], L_setup
    v_and_b32 v26, 7, v2
    v_xor_b32 v24, v26, v3
    v_xor_b32 v25, 4, v24
    v_lshlrev_b32 v26, 7, v26
    v_lshrrev_b32 v27, 3, v2
    v_lshl_add_u32 v26, v27, 12, v26
    s_lshl_b32 s6, s3, 13
    s_add_u32 s6, s6, 98304
    v_add_u32 v26, s6, v26
    v_lshl_add_u32 v24, v24, 4, v26
    v_lshl_add_u32 v25, v25, 4, v26
    v_and_b32 v36, 1, v2
    v_lshlrev_b32 v27, 12, v36
    v_lshlrev_b32 v26, 9, v36
    v_lshl_add_u32 v26, v3, 4, v26
    v_lshrrev_b32 v37, 1, v2
    v_lshlrev_b32 v37, 3, v37
    v_lshrrev_b32 v38, 1, v3
    v_add_u32 v37, v37, v38
    s_lshl_b32 s6, s3, 1
    s_add_u32 s6, s6, s69
    v_add_u32 v37, s6, v37
    v_and_b32 v37, 15, v37
    v_lshl_add_u32 v27, v37, 5, v27
    v_and_b32 v38, 1, v3
    v_lshl_add_u32 v27, v38, 4, v27
    s_lshl_b32 s67, s55, 13
    s_lshl_b32 s6, s59, 9
    s_add_u32 s67, s67, s6
    s_add_u32 s67, s67, 606208
    s_lshl_b32 s56, s3, 3
    s_add_u32 s56, s56, 26
    s_add_u32 s57, s56, 32
    v_and_b32 v38, 2, v2
    v_cmp_ne_u32 s[60:61], 0, v38
    v_lshlrev_b32 v38, 6, v36
    v_lshlrev_b32 v37, 10, v36
    v_lshl_add_u32 v37, v3, 4, v37
    v_lshl_add_u32 v38, v3, 4, v38
    v_xor_b32 v36, s3, v45
    v_lshl_add_u32 v36, v36, 5, v44
    v_add_u32 v36, 32768, v36
    v_mov_b32 v39, 0xffff0000
    s_lshl_b32 s68, s66, 16
    s_lshr_b32 s6, s55, 3
    s_lshl_b32 s6, s6, 14
    s_add_u32 s68, s68, s6
    s_lshl_b32 s6, s4, 11
    s_add_u32 s68, s68, s6
    s_lshl_b32 s6, s65, 9
    s_add_u32 s68, s68, s6
    s_lshl_b32 s6, s3, 7
    s_add_u32 s68, s68, s6
    s_add_u32 s68, s68, 344064
    s_mov_b64 exec, -1
    s_mov_b32 s7, 4194304
L_spin_12:
    ds_read_b32 v7, v5 offset:0
    s_sub_u32 s7, s7, 1
    s_cbranch_scc1 L_end
    s_waitcnt lgkmcnt(0)
    v_cmp_gt_u32 vcc, s56, v7
    s_cbranch_vccz L_spind_13
    s_sleep 1
    s_branch L_spin_12
L_spind_13:
    ds_read_b128 v[64:67], v24 offset:0
    ds_read_b128 v[68:71], v25 offset:0
    ds_read_b128 v[72:75], v24 offset:1024
    ds_read_b128 v[76:79], v25 offset:1024
    ds_read_b128 v[80:83], v24 offset:2048
    ds_read_b128 v[84:87], v25 offset:2048
    ds_read_b128 v[88:91], v24 offset:3072
    ds_read_b128 v[92:95], v25 offset:3072
    s_mov_b32 s7, 4194304
L_spin_14:
    ds_read_b32 v7, v5 offset:8
    s_sub_u32 s7, s7, 1
    s_cbranch_scc1 L_end
    s_waitcnt lgkmcnt(0)
    v_cmp_gt_u32 vcc, 1, v7
    s_cbranch_vccz L_spind_15
    s_sleep 1
    s_branch L_spin_14
L_spind_15:
    v_readfirstlane_b32 s42, v7
    s_cmp_eq_u32 s42, 1
    s_cbranch_scc1 L_qok
    s_cmp_ge_u32 s3, 2
    s_cbranch_scc1 L_qok
    s_mov_b32 exec_lo, 0xff00ff
    s_mov_b32 exec_hi, 0xff00ff
    buffer_store_dwordx4 v[32:35], v42, s[36:39], s58 offen sc1
    s_mov_b64 exec, -1
L_qok:
    s_mov_b32 s7, 4194304
L_spin_16:
    ds_read_b32 v7, v5 offset:12
    ds_read_b32 v40, v5 offset:0
    s_sub_u32 s7, s7, 1
    s_cbranch_scc1 L_end
    s_waitcnt lgkmcnt(0)
    v_cmp_le_u32 vcc, 2, v7
    s_cbranch_vccnz L_qfirst
    v_cmp_gt_u32 vcc, s57, v40
    s_cbranch_vccnz L_spin_16
    ds_read_b128 v[96:99], v24 offset:32768
    ds_read_b128 v[100:103], v25 offset:32768
    ds_read_b128 v[104:107], v24 offset:33792
    ds_read_b128 v[108:111], v25 offset:33792
    ds_read_b128 v[112:115], v24 offset:34816
    ds_read_b128 v[116:119], v25 offset:34816
    ds_read_b128 v[120:123], v24 offset:35840
    ds_read_b128 v[124:127], v25 offset:35840
    s_mov_b32 s7, 4194304
L_spin_17:
    ds_read_b32 v7, v5 offset:12
    ds_read_b128 v[128:131], v26 offset:3648
    ds_read_b128 v[132:135], v26 offset:3712
    ds_read_b128 v[136:139], v26 offset:3776
    ds_read_b128 v[140:143], v26 offset:3840
    ds_read_b128 v[144:147], v26 offset:3904
    ds_read_b128 v[148:151], v26 offset:3968
    ds_read_b128 v[152:155], v26 offset:4032
    ds_read_b128 v[156:159], v26 offset:4096
    s_sub_u32 s7, s7, 1
    s_cbranch_scc1 L_end
    s_waitcnt lgkmcnt(0)
    v_cmp_gt_u32 vcc, 2, v7
    s_cbranch_vccnz L_spin_17
    v_mfma_f32_16x16x32_bf16 v[28:31], v[64:67], v[128:131], 0
    v_mfma_f32_16x16x32_bf16 v[32:35], v[96:99], v[128:131], 0
    v_mfma_f32_16x16x32_bf16 v[28:31], v[68:71], v[132:135], v[28:31]
    v_mfma_f32_16x16x32_bf16 v[32:35], v[100:103], v[132:135], v[32:35]
    v_mfma_f32_16x16x32_bf16 v[28:31], v[72:75], v[136:139], v[28:31]
    v_mfma_f32_16x16x32_bf16 v[32:35], v[104:107], v[136:139], v[32:35]
    v_mfma_f32_16x16x32_bf16 v[28:31], v[76:79], v[140:143], v[28:31]
    v_mfma_f32_16x16x32_bf16 v[32:35], v[108:111], v[140:143], v[32:35]
    v_mfma_f32_16x16x32_bf16 v[28:31], v[80:83], v[144:147], v[28:31]
    v_mfma_f32_16x16x32_bf16 v[32:35], v[112:115], v[144:147], v[32:35]
    v_mfma_f32_16x16x32_bf16 v[28:31], v[84:87], v[148:151], v[28:31]
    v_mfma_f32_16x16x32_bf16 v[32:35], v[116:119], v[148:151], v[32:35]
    v_mfma_f32_16x16x32_bf16 v[28:31], v[88:91], v[152:155], v[28:31]
    v_mfma_f32_16x16x32_bf16 v[32:35], v[120:123], v[152:155], v[32:35]
    v_mfma_f32_16x16x32_bf16 v[28:31], v[92:95], v[156:159], v[28:31]
    v_mfma_f32_16x16x32_bf16 v[32:35], v[124:127], v[156:159], v[32:35]
    s_branch L_qkdone
L_qfirst:
    ds_read_b128 v[128:131], v26 offset:3648
    ds_read_b128 v[132:135], v26 offset:3712
    ds_read_b128 v[136:139], v26 offset:3776
    ds_read_b128 v[140:143], v26 offset:3840
    ds_read_b128 v[144:147], v26 offset:3904
    ds_read_b128 v[148:151], v26 offset:3968
    ds_read_b128 v[152:155], v26 offset:4032
    ds_read_b128 v[156:159], v26 offset:4096
    ds_read_b32 v40, v5 offset:0
    ds_read_b128 v[96:99], v24 offset:32768
    ds_read_b128 v[100:103], v25 offset:32768
    ds_read_b128 v[104:107], v24 offset:33792
    s_waitcnt lgkmcnt(11)
    v_mfma_f32_16x16x32_bf16 v[28:31], v[64:67], v[128:131], 0
    ds_read_b128 v[108:111], v25 offset:33792
    ds_read_b128 v[112:115], v24 offset:34816
    s_waitcnt lgkmcnt(12)
    v_mfma_f32_16x16x32_bf16 v[28:31], v[68:71], v[132:135], v[28:31]
    ds_read_b128 v[116:119], v25 offset:34816
    ds_read_b128 v[120:123], v24 offset:35840
    s_waitcnt lgkmcnt(13)
    v_mfma_f32_16x16x32_bf16 v[28:31], v[72:75], v[136:139], v[28:31]
    ds_read_b128 v[124:127], v25 offset:35840
    s_waitcnt lgkmcnt(13)
    v_mfma_f32_16x16x32_bf16 v[28:31], v[76:79], v[140:143], v[28:31]
    s_waitcnt lgkmcnt(12)
    v_mfma_f32_16x16x32_bf16 v[28:31], v[80:83], v[144:147], v[28:31]
    s_waitcnt lgkmcnt(11)
    v_mfma_f32_16x16x32_bf16 v[28:31], v[84:87], v[148:151], v[28:31]
    s_waitcnt lgkmcnt(10)
    v_mfma_f32_16x16x32_bf16 v[28:31], v[88:91], v[152:155], v[28:31]
    s_waitcnt lgkmcnt(9)
    v_mfma_f32_16x16x32_bf16 v[28:31], v[92:95], v[156:159], v[28:31]
    s_waitcnt lgkmcnt(0)
    v_cmp_le_u32 vcc, s57, v40
    s_cbranch_vccnz L_kready
    s_mov_b32 s7, 4194304
L_spin_18:
    ds_read_b32 v7, v5 offset:0
    ds_read_b128 v[96:99], v24 offset:32768
    ds_read_b128 v[100:103], v25 offset:32768
    ds_read_b128 v[104:107], v24 offset:33792
    ds_read_b128 v[108:111], v25 offset:33792
    ds_read_b128 v[112:115], v24 offset:34816
    ds_read_b128 v[116:119], v25 offset:34816
    ds_read_b128 v[120:123], v24 offset:35840
    ds_read_b128 v[124:127], v25 offset:35840
    s_sub_u32 s7, s7, 1
    s_cbranch_scc1 L_end
    s_waitcnt lgkmcnt(0)
    v_cmp_gt_u32 vcc, s57, v7
    s_cbranch_vccnz L_spin_18
L_kready:
    v_mfma_f32_16x16x32_bf16 v[32:35], v[96:99], v[128:131], 0
    v_mfma_f32_16x16x32_bf16 v[32:35], v[100:103], v[132:135], v[32:35]
    v_mfma_f32_16x16x32_bf16 v[32:35], v[104:107], v[136:139], v[32:35]
    v_mfma_f32_16x16x32_bf16 v[32:35], v[108:111], v[140:143], v[32:35]
    v_mfma_f32_16x16x32_bf16 v[32:35], v[112:115], v[144:147], v[32:35]
    v_mfma_f32_16x16x32_bf16 v[32:35], v[116:119], v[148:151], v[32:35]
    v_mfma_f32_16x16x32_bf16 v[32:35], v[120:123], v[152:155], v[32:35]
    v_mfma_f32_16x16x32_bf16 v[32:35], v[124:127], v[156:159], v[32:35]
L_qkdone:
    s_mov_b64 exec, 1
    ds_add_u32 v5, v6 offset:24
    s_mov_b64 exec, -1
    s_nop 4
    v_cndmask_b32 v28, v28, v32, s[60:61]
    v_cndmask_b32 v29, v29, v33, s[60:61]
    v_cndmask_b32 v30, v30, v34, s[60:61]
    v_cndmask_b32 v31, v31, v35, s[60:61]
    v_cvt_pk_bf16_f32 v32, v28, v29
    v_cvt_pk_bf16_f32 v33, v30, v31
    v_lshl_or_b32 v28, v32, 16, s48
    v_and_or_b32 v29, v32, v39, s49
    v_lshl_or_b32 v30, v33, 16, s50
    v_and_or_b32 v31, v33, v39, s51
    s_mov_b32 exec_lo, 0xf000f
    s_mov_b32 exec_hi, 0xf000f
    s_cmp_lg_u32 s42, 1
    s_cbranch_scc1 L_slow_19
    buffer_store_dwordx4 v[28:31], v27, s[36:39], s67 offen
    s_branch L_pubd_20
L_slow_19:
    buffer_store_dwordx4 v[28:31], v27, s[36:39], s67 offen sc1
L_pubd_20:
    s_mov_b64 exec, 1
    ds_add_u32 v5, v6 offset:16
    s_mov_b64 exec, -1
    s_add_u32 s34, s34, 0x9E3779B9
    s_and_b32 s48, s34, 0xff
    s_bfe_u32 s49, s34, 0x80008
    s_bfe_u32 s50, s34, 0x80010
    s_lshr_b32 s51, s34, 24
    s_mov_b32 s7, 4194304
L_spin_21:
    ds_read_b32 v7, v5 offset:0
    s_sub_u32 s7, s7, 1
    s_cbranch_scc1 L_end
    s_waitcnt lgkmcnt(0)
    v_cmp_gt_u32 vcc, 0x7a, v7
    s_cbranch_vccz L_spind_22
    s_sleep 1
    s_branch L_spin_21
L_spind_22:
    ds_read_b64_tr_b16 v[40:41], v36 offset:0
    ds_read_b64_tr_b16 v[42:43], v36 offset:2048
    ds_read_b64_tr_b16 v[44:45], v36 offset:4096
    ds_read_b64_tr_b16 v[46:47], v36 offset:6144
    ds_read_b64_tr_b16 v[48:49], v36 offset:8192
    ds_read_b64_tr_b16 v[50:51], v36 offset:10240
    ds_read_b64_tr_b16 v[52:53], v36 offset:12288
    ds_read_b64_tr_b16 v[54:55], v36 offset:14336
    ds_read_b64_tr_b16 v[56:57], v36 offset:16384
    ds_read_b64_tr_b16 v[58:59], v36 offset:18432
    ds_read_b64_tr_b16 v[60:61], v36 offset:20480
    ds_read_b64_tr_b16 v[62:63], v36 offset:22528
    ds_read_b64_tr_b16 v[64:65], v36 offset:24576
    ds_read_b64_tr_b16 v[66:67], v36 offset:26624
    ds_read_b64_tr_b16 v[68:69], v36 offset:28672
    ds_read_b64_tr_b16 v[70:71], v36 offset:30720
    ds_read_b64_tr_b16 v[72:73], v36 offset:32768
    ds_read_b64_tr_b16 v[74:75], v36 offset:34816
    ds_read_b64_tr_b16 v[76:77], v36 offset:36864
    ds_read_b64_tr_b16 v[78:79], v36 offset:38912
    s_mov_b32 s7, 4194304
L_spin_23:
    ds_read_b32 v7, v5 offset:20
    ds_read_b32 v24, v5 offset:0
    s_sub_u32 s7, s7, 1
    s_cbranch_scc1 L_end
    s_waitcnt lgkmcnt(0)
    v_cmp_le_u32 vcc, 2, v7
    s_cbranch_vccnz L_pfirst
    v_cmp_gt_u32 vcc, 0x92, v24
    s_cbranch_vccnz L_spin_23
    ds_read_b64_tr_b16 v[80:81], v36 offset:40960
    ds_read_b64_tr_b16 v[82:83], v36 offset:43008
    ds_read_b64_tr_b16 v[84:85], v36 offset:45056
    ds_read_b64_tr_b16 v[86:87], v36 offset:47104
    ds_read_b64_tr_b16 v[88:89], v36 offset:49152
    ds_read_b64_tr_b16 v[90:91], v36 offset:51200
    ds_read_b64_tr_b16 v[92:93], v36 offset:53248
    ds_read_b64_tr_b16 v[94:95], v36 offset:55296
    ds_read_b64_tr_b16 v[96:97], v36 offset:57344
    ds_read_b64_tr_b16 v[98:99], v36 offset:59392
    ds_read_b64_tr_b16 v[100:101], v36 offset:61440
    ds_read_b64_tr_b16 v[102:103], v36 offset:63488
    s_mov_b64 exec, 1
    ds_add_u32 v5, v6 offset:28
    s_mov_b64 exec, -1
    v_mov_b32 v6, 0
    s_mov_b32 s7, 4194304
L_spin_24:
    ds_read_b32 v7, v5 offset:20
    s_sub_u32 s7, s7, 1
    s_cbranch_scc1 L_end
    s_waitcnt lgkmcnt(0)
    v_cmp_gt_u32 vcc, 2, v7
    s_cbranch_vccnz L_spin_24
    ds_read_b128 v[104:107], v37 offset:19072
    ds_read_b128 v[108:111], v37 offset:19136
    ds_read_b128 v[112:115], v37 offset:19200
    ds_read_b128 v[116:119], v37 offset:19264
    ds_read_b128 v[120:123], v37 offset:19328
    ds_read_b128 v[124:127], v37 offset:19392
    ds_read_b128 v[128:131], v37 offset:19456
    ds_read_b128 v[132:135], v37 offset:19520
    ds_read_b128 v[136:139], v37 offset:19584
    ds_read_b128 v[140:143], v37 offset:19648
    ds_read_b128 v[144:147], v37 offset:19712
    ds_read_b128 v[148:151], v37 offset:19776
    s_waitcnt lgkmcnt(11)
    v_mfma_f32_16x16x32_bf16 v[32:35], v[40:43], v[104:107], 0
    ds_read_b128 v[152:155], v37 offset:19840
    ds_read_b128 v[156:159], v37 offset:19904
    s_waitcnt lgkmcnt(12)
    v_mfma_f32_16x16x32_bf16 v[32:35], v[44:47], v[108:111], v[32:35]
    ds_read_b128 v[160:163], v37 offset:19968
    ds_read_b128 v[164:167], v37 offset:20032
    s_waitcnt lgkmcnt(13)
    v_mfma_f32_16x16x32_bf16 v[32:35], v[48:51], v[112:115], v[32:35]
    s_waitcnt lgkmcnt(12)
    v_mfma_f32_16x16x32_bf16 v[32:35], v[52:55], v[116:119], v[32:35]
    s_waitcnt lgkmcnt(11)
    v_mfma_f32_16x16x32_bf16 v[32:35], v[56:59], v[120:123], v[32:35]
    s_waitcnt lgkmcnt(10)
    v_mfma_f32_16x16x32_bf16 v[32:35], v[60:63], v[124:127], v[32:35]
    s_waitcnt lgkmcnt(9)
    v_mfma_f32_16x16x32_bf16 v[32:35], v[64:67], v[128:131], v[32:35]
    s_waitcnt lgkmcnt(8)
    v_mfma_f32_16x16x32_bf16 v[32:35], v[68:71], v[132:135], v[32:35]
    s_waitcnt lgkmcnt(7)
    v_mfma_f32_16x16x32_bf16 v[32:35], v[72:75], v[136:139], v[32:35]
    s_waitcnt lgkmcnt(6)
    v_mfma_f32_16x16x32_bf16 v[32:35], v[76:79], v[140:143], v[32:35]
    s_waitcnt lgkmcnt(5)
    v_mfma_f32_16x16x32_bf16 v[32:35], v[80:83], v[144:147], v[32:35]
    s_waitcnt lgkmcnt(4)
    v_mfma_f32_16x16x32_bf16 v[32:35], v[84:87], v[148:151], v[32:35]
    s_waitcnt lgkmcnt(3)
    v_mfma_f32_16x16x32_bf16 v[32:35], v[88:91], v[152:155], v[32:35]
    s_waitcnt lgkmcnt(2)
    v_mfma_f32_16x16x32_bf16 v[32:35], v[92:95], v[156:159], v[32:35]
    s_waitcnt lgkmcnt(1)
    v_mfma_f32_16x16x32_bf16 v[32:35], v[96:99], v[160:163], v[32:35]
    s_waitcnt lgkmcnt(0)
    v_mfma_f32_16x16x32_bf16 v[32:35], v[100:103], v[164:167], v[32:35]
    s_branch L_pvdone
L_pfirst:
    ds_read_b128 v[104:107], v37 offset:19072
    ds_read_b128 v[108:111], v37 offset:19136
    ds_read_b128 v[112:115], v37 offset:19200
    ds_read_b128 v[116:119], v37 offset:19264
    ds_read_b128 v[120:123], v37 offset:19328
    ds_read_b128 v[124:127], v37 offset:19392
    ds_read_b128 v[128:131], v37 offset:19456
    ds_read_b128 v[132:135], v37 offset:19520
    ds_read_b128 v[136:139], v37 offset:19584
    ds_read_b128 v[140:143], v37 offset:19648
    ds_read_b128 v[144:147], v37 offset:19712
    ds_read_b128 v[148:151], v37 offset:19776
    s_waitcnt lgkmcnt(11)
    v_mfma_f32_16x16x32_bf16 v[32:35], v[40:43], v[104:107], 0
    ds_read_b128 v[152:155], v37 offset:19840
    ds_read_b128 v[156:159], v37 offset:19904
    s_waitcnt lgkmcnt(12)
    v_mfma_f32_16x16x32_bf16 v[32:35], v[44:47], v[108:111], v[32:35]
    ds_read_b128 v[160:163], v37 offset:19968
    ds_read_b128 v[164:167], v37 offset:20032
    s_waitcnt lgkmcnt(13)
    v_mfma_f32_16x16x32_bf16 v[32:35], v[48:51], v[112:115], v[32:35]
    ds_read_b32 v24, v5 offset:0
    s_waitcnt lgkmcnt(13)
    v_mfma_f32_16x16x32_bf16 v[32:35], v[52:55], v[116:119], v[32:35]
    ds_read_b64_tr_b16 v[80:81], v36 offset:40960
    s_waitcnt lgkmcnt(13)
    v_mfma_f32_16x16x32_bf16 v[32:35], v[56:59], v[120:123], v[32:35]
    ds_read_b64_tr_b16 v[82:83], v36 offset:43008
    s_waitcnt lgkmcnt(13)
    v_mfma_f32_16x16x32_bf16 v[32:35], v[60:63], v[124:127], v[32:35]
    ds_read_b64_tr_b16 v[84:85], v36 offset:45056
    s_waitcnt lgkmcnt(13)
    v_mfma_f32_16x16x32_bf16 v[32:35], v[64:67], v[128:131], v[32:35]
    ds_read_b64_tr_b16 v[86:87], v36 offset:47104
    s_waitcnt lgkmcnt(13)
    v_mfma_f32_16x16x32_bf16 v[32:35], v[68:71], v[132:135], v[32:35]
    ds_read_b64_tr_b16 v[88:89], v36 offset:49152
    s_waitcnt lgkmcnt(13)
    v_mfma_f32_16x16x32_bf16 v[32:35], v[72:75], v[136:139], v[32:35]
    ds_read_b64_tr_b16 v[90:91], v36 offset:51200
    s_waitcnt lgkmcnt(13)
    v_mfma_f32_16x16x32_bf16 v[32:35], v[76:79], v[140:143], v[32:35]
    ds_read_b64_tr_b16 v[92:93], v36 offset:53248
    ds_read_b64_tr_b16 v[94:95], v36 offset:55296
    ds_read_b64_tr_b16 v[96:97], v36 offset:57344
    ds_read_b64_tr_b16 v[98:99], v36 offset:59392
    ds_read_b64_tr_b16 v[100:101], v36 offset:61440
    ds_read_b64_tr_b16 v[102:103], v36 offset:63488
    s_waitcnt lgkmcnt(0)
    v_cmp_gt_u32 vcc, 0x92, v24
    s_cbranch_vccnz L_pvslow
    v_mfma_f32_16x16x32_bf16 v[32:35], v[80:83], v[144:147], v[32:35]
    v_mfma_f32_16x16x32_bf16 v[32:35], v[84:87], v[148:151], v[32:35]
    v_mfma_f32_16x16x32_bf16 v[32:35], v[88:91], v[152:155], v[32:35]
    v_mfma_f32_16x16x32_bf16 v[32:35], v[92:95], v[156:159], v[32:35]
    v_mfma_f32_16x16x32_bf16 v[32:35], v[96:99], v[160:163], v[32:35]
    s_branch L_pvlast
L_pvslow:
    s_mov_b32 s7, 4194304
L_spin_25:
    ds_read_b32 v7, v5 offset:0
    ds_read_b64_tr_b16 v[80:81], v36 offset:40960
    ds_read_b64_tr_b16 v[82:83], v36 offset:43008
    ds_read_b64_tr_b16 v[84:85], v36 offset:45056
    ds_read_b64_tr_b16 v[86:87], v36 offset:47104
    ds_read_b64_tr_b16 v[88:89], v36 offset:49152
    ds_read_b64_tr_b16 v[90:91], v36 offset:51200
    ds_read_b64_tr_b16 v[92:93], v36 offset:53248
    ds_read_b64_tr_b16 v[94:95], v36 offset:55296
    ds_read_b64_tr_b16 v[96:97], v36 offset:57344
    ds_read_b64_tr_b16 v[98:99], v36 offset:59392
    s_sub_u32 s7, s7, 1
    s_cbranch_scc1 L_end
    s_waitcnt lgkmcnt(0)
    v_cmp_gt_u32 vcc, 0x8e, v7
    s_cbranch_vccnz L_spin_25
    v_mfma_f32_16x16x32_bf16 v[32:35], v[80:83], v[144:147], v[32:35]
    v_mfma_f32_16x16x32_bf16 v[32:35], v[84:87], v[148:151], v[32:35]
    v_mfma_f32_16x16x32_bf16 v[32:35], v[88:91], v[152:155], v[32:35]
    v_mfma_f32_16x16x32_bf16 v[32:35], v[92:95], v[156:159], v[32:35]
    v_mfma_f32_16x16x32_bf16 v[32:35], v[96:99], v[160:163], v[32:35]
    s_mov_b32 s7, 4194304
L_spin_26:
    ds_read_b32 v7, v5 offset:0
    ds_read_b64_tr_b16 v[100:101], v36 offset:61440
    ds_read_b64_tr_b16 v[102:103], v36 offset:63488
    s_sub_u32 s7, s7, 1
    s_cbranch_scc1 L_end
    s_waitcnt lgkmcnt(0)
    v_cmp_gt_u32 vcc, 0x92, v7
    s_cbranch_vccnz L_spin_26
L_pvlast:
    v_mfma_f32_16x16x32_bf16 v[32:35], v[100:103], v[164:167], v[32:35]
L_pvdone:
    s_mov_b32 exec_lo, 0x30003
    s_mov_b32 exec_hi, 0x30003
    s_nop 5
    v_bfi_b32 v32, v4, s48, v32
    v_bfi_b32 v33, v4, s49, v33
    v_bfi_b32 v34, v4, s50, v34
    v_bfi_b32 v35, v4, s51, v35
    s_cmp_lg_u32 s42, 1
    s_cbranch_scc1 L_slow_27
    buffer_store_dwordx4 v[32:35], v38, s[36:39], s68 offen
    s_branch L_pubd_28
L_slow_27:
    buffer_store_dwordx4 v[32:35], v38, s[36:39], s68 offen sc1
L_pubd_28:
    s_mov_b64 exec, 1
    ds_add_u32 v5, v6 offset:28
    s_mov_b64 exec, -1
    v_mov_b32 v6, 1
    s_branch L_tail2
L_comm:
    s_sub_u32 s52, s3, 4
    s_cmp_lt_u32 s52, 2
    s_cbranch_scc1 L_comm2
    s_waitcnt lgkmcnt(0)
    s_add_u32 s34, s34, 0x9E3779B9
    s_and_b32 s48, s34, 0xff
    s_bfe_u32 s49, s34, 0x80008
    s_bfe_u32 s50, s34, 0x80010
    s_lshr_b32 s51, s34, 24
    s_mov_b64 exec, 1
    ds_add_u32 v5, v6 offset:4
    s_mov_b64 exec, -1
    s_cmp_lg_u32 s3, 6
    s_cbranch_scc1 L_hello_skip
    s_getreg_b32 s6, hwreg(HW_REG_XCC_ID, 0, 4)
    s_and_b32 s64, s34, 0xfffffff0
    s_or_b32 s64, s64, s6
    s_lshl_b32 s57, s4, 7
    s_add_u32 s57, s57, 4096
    s_lshl_b32 s6, s5, 2
    v_mov_b32 v10, s6
    v_mov_b32 v11, s64
    v_mov_b32 v13, 1
    v_and_b32 v12, 31, v1
    v_lshlrev_b32 v12, 2, v12
    s_mov_b64 exec, 1
    buffer_store_dword v11, v10, s[36:39], s57 offen
    s_mov_b64 exec, -1
    s_mov_b32 s7, 4194304
L_spin_29:
    ds_read_b32 v7, v5 offset:0
    s_sub_u32 s7, s7, 1
    s_cbranch_scc1 L_end
    s_waitcnt lgkmcnt(0)
    v_cmp_gt_u32 vcc, 42, v7
    s_cbranch_vccz L_spind_30
    s_sleep 1
    s_branch L_spin_29
L_spind_30:
    s_mov_b32 s7, 8
L_hello:
    buffer_load_dword v20, v12, s[36:39], s57 offen sc1
    s_waitcnt vmcnt(0)
    v_cmp_ne_u32 vcc, s64, v20
    s_cbranch_vccz L_hello_ok
    s_sub_u32 s7, s7, 1
    s_cmp_lg_u32 s7, 0
    s_cbranch_scc1 L_hello
    v_mov_b32 v13, 2
L_hello_ok:
    ds_write_b32 v5, v13 offset:8
L_hello_skip:
    s_call_b64 s[44:45], L_setup
    s_add_u32 s34, s34, 0x9E3779B9
    s_and_b32 s48, s34, 0xff
    s_bfe_u32 s49, s34, 0x80008
    s_bfe_u32 s50, s34, 0x80010
    s_lshr_b32 s51, s34, 24
    s_cmp_lg_u32 s43, 3
    s_cbranch_scc1 L_tail
    v_lshrrev_b32 v24, 3, v1
    v_and_b32 v25, 7, v1
    v_and_b32 v26, 6, v24
    v_xor_b32 v25, v25, v26
    v_mul_u32_u24 v24, 896, v24
    v_lshl_add_u32 v24, v25, 4, v24
    s_mov_b64 s[56:57], s[24:25]
    s_mov_b32 s58, 1605632
    s_mov_b32 s59, 0x20000
    s_mul_i32 s61, s40, 57344
    s_lshl_b32 s6, s41, 8
    s_add_u32 s60, s61, s6
    s_lshl_b32 s6, s41, 14
    s_add_u32 m0, s6, 32768
    s_mov_b32 s62, 7
    s_mov_b32 s7, 4194304
L_spin_31:
    ds_read_b32 v7, v5 offset:8
    s_sub_u32 s7, s7, 1
    s_cbranch_scc1 L_end
    s_waitcnt lgkmcnt(0)
    v_cmp_gt_u32 vcc, 1, v7
    s_cbranch_vccz L_spind_32
    s_sleep 1
    s_branch L_spin_31
L_spind_32:
    v_readfirstlane_b32 s42, v7
    s_mov_b32 s7, 4194304
L_spin_33:
    ds_read_b32 v7, v5 offset:0
    s_sub_u32 s7, s7, 1
    s_cbranch_scc1 L_end
    s_waitcnt lgkmcnt(0)
    v_cmp_gt_u32 vcc, 0x82, v7
    s_cbranch_vccz L_spind_34
    s_sleep 2
    s_branch L_spin_33
L_spind_34:
    s_mov_b32 s7, 4194304
L_spin_35:
    ds_read_b32 v7, v5 offset:28
    s_sub_u32 s7, s7, 1
    s_cbranch_scc1 L_end
    s_waitcnt lgkmcnt(0)
    v_cmp_gt_u32 vcc, 4, v7
    s_cbranch_vccz L_spind_36
    s_sleep 1
    s_branch L_spin_35
L_spind_36:
L_l2l:
    s_waitcnt vmcnt(24)
    buffer_load_dwordx4 v24, s[56:59], s60 offen  lds
    s_add_u32 m0, m0, 1024
    s_addk_i32 s60, 7168
    buffer_load_dwordx4 v24, s[56:59], s60 offen  lds
    s_add_u32 m0, m0, 1024
    s_addk_i32 s60, 7168
    buffer_load_dwordx4 v24, s[56:59], s60 offen  lds
    s_add_u32 m0, m0, 1024
    s_addk_i32 s60, 7168
    buffer_load_dwordx4 v24, s[56:59], s60 offen  lds
    s_add_u32 m0, m0, 1024
    s_addk_i32 s60, 7168
    buffer_load_dwordx4 v24, s[56:59], s60 offen  lds
    s_add_u32 m0, m0, 1024
    s_addk_i32 s60, 7168
    buffer_load_dwordx4 v24, s[56:59], s60 offen  lds
    s_add_u32 m0, m0, 1024
    s_addk_i32 s60, 7168
    buffer_load_dwordx4 v24, s[56:59], s60 offen  lds
    s_add_u32 m0, m0, 1024
    s_addk_i32 s60, 7168
    buffer_load_dwordx4 v24, s[56:59], s60 offen  lds
    s_add_u32 m0, m0, 1024
    s_addk_i32 s60, 7168
    s_sub_u32 s60, s60, 57216
    s_cmp_lg_u32 m0, 90112
    s_cbranch_scc1 L_l2n
    s_mov_b32 m0, 32768
    s_mov_b32 s60, s61
L_l2n:
    s_sub_u32 s62, s62, 1
    s_cmp_lg_u32 s62, 0
    s_cbranch_scc1 L_l2l
    s_waitcnt vmcnt(0)
    s_mov_b64 exec, 1
    ds_add_u32 v5, v6 offset:36
    s_mov_b64 exec, -1
    s_branch L_final
L_comm2:
    s_waitcnt lgkmcnt(0)
    s_add_u32 s34, s34, 0x9E3779B9
    s_and_b32 s48, s34, 0xff
    s_bfe_u32 s49, s34, 0x80008
    s_bfe_u32 s50, s34, 0x80010
    s_lshr_b32 s51, s34, 24
    s_call_b64 s[44:45], L_setup
    s_lshr_b32 s56, s55, 3
    s_lshl_b32 s56, s56, 14
    s_lshl_b32 s6, s4, 11
    s_add_u32 s56, s56, s6
    s_lshl_b32 s6, s52, 10
    s_add_u32 s56, s56, s6
    s_add_u32 s56, s56, 344064
    s_add_u32 s57, s56, 0x10000
    s_add_u32 s58, s56, 0x20000
    s_add_u32 s59, s56, 0x30000
    v_lshlrev_b32 v48, 4, v1
    s_lshl_b32 s6, s52, 9
    s_add_u32 s6, s6, 3648
    v_lshl_add_u32 v49, v1, 3, s6
    s_mov_b32 s7, 4194304
L_spin_37:
    ds_read_b32 v7, v5 offset:0
    s_sub_u32 s7, s7, 1
    s_cbranch_scc1 L_end
    s_waitcnt lgkmcnt(0)
    v_cmp_gt_u32 vcc, 42, v7
    s_cbranch_vccz L_spind_38
    s_sleep 1
    s_branch L_spin_37
L_spind_38:
    s_lshl_b32 s60, s55, 13
    s_lshr_b32 s6, s5, 2
    s_lshl_b32 s6, s6, 9
    s_add_u32 s60, s60, s6
    s_lshl_b32 s6, s52, 12
    s_add_u32 s60, s60, s6
    s_add_u32 s60, s60, 606208
    v_lshlrev_b32 v50, 7, v1
    s_mov_b64 exec, 15
    buffer_load_dword v0, v50, s[36:39], s60 offen sc1
    s_mov_b64 exec, -1
    s_mov_b32 s7, 4194304
L_pp_39:
    buffer_load_dwordx4 v[64:67], v48, s[36:39], s56 offen sc1
    buffer_load_dwordx4 v[68:71], v48, s[36:39], s57 offen sc1
    buffer_load_dwordx4 v[72:75], v48, s[36:39], s58 offen sc1
    buffer_load_dwordx4 v[76:79], v48, s[36:39], s59 offen sc1
    s_sub_u32 s7, s7, 1
    s_cbranch_scc1 L_end
    s_waitcnt vmcnt(0)
    v_xor_b32 v32, s48, v64
    v_xor_b32 v33, s49, v65
    v_xor_b32 v34, s50, v66
    v_xor_b32 v35, s51, v67
    v_xor_b32 v36, s48, v68
    v_xor_b32 v37, s49, v69
    v_xor_b32 v38, s50, v70
    v_xor_b32 v39, s51, v71
    v_xor_b32 v40, s48, v72
    v_xor_b32 v41, s49, v73
    v_xor_b32 v42, s50, v74
    v_xor_b32 v43, s51, v75
    v_xor_b32 v44, s48, v76
    v_xor_b32 v45, s49, v77
    v_xor_b32 v46, s50, v78
    v_xor_b32 v47, s51, v79
    v_or3_b32 v24, v32, v33, v34
    v_or3_b32 v24, v24, v35, v36
    v_or3_b32 v24, v24, v37, v38
    v_or3_b32 v24, v24, v39, v40
    v_or3_b32 v24, v24, v41, v42
    v_or3_b32 v24, v24, v43, v44
    v_or3_b32 v24, v24, v45, v46
    v_or_b32 v24, v24, v47
    v_and_b32 v24, v4, v24
    v_cmp_ne_u32 vcc, 0, v24
    s_cbranch_vccnz L_pp_39
L_ppd_40:
    v_pk_add_f32 v[32:33], v[32:33], v[36:37]
    v_pk_add_f32 v[34:35], v[34:35], v[38:39]
    v_pk_add_f32 v[40:41], v[40:41], v[44:45]
    v_pk_add_f32 v[42:43], v[42:43], v[46:47]
    v_pk_add_f32 v[32:33], v[32:33], v[40:41]
    v_pk_add_f32 v[34:35], v[34:35], v[42:43]
    v_cvt_pk_bf16_f32 v32, v32, v33
    v_cvt_pk_bf16_f32 v33, v34, v35
    ds_write_b64 v49, v[32:33]
    s_mov_b64 exec, 1
    ds_add_u32 v5, v6 offset:12
    s_mov_b64 exec, -1
    s_lshl_b32 s56, s55, 13
    s_lshl_b32 s6, s52, 12
    s_add_u32 s56, s56, s6
    s_add_u32 s56, s56, 606208
    s_lshl_b32 s6, s66, 11
    s_add_u32 s57, s56, s6
    s_xor_b32 s6, s6, 2048
    s_add_u32 s58, s56, s6
    v_lshrrev_b32 v49, 3, v1
    v_lshlrev_b32 v49, 6, v49
    v_and_b32 v50, 3, v1
    v_lshl_add_u32 v49, v50, 4, v49
    v_bfe_u32 v50, v1, 2, 1
    v_lshl_add_u32 v49, v50, 3, v49
    s_lshl_b32 s6, s52, 10
    s_add_u32 s6, s6, 19072
    v_add_u32 v49, s6, v49
    s_mov_b32 s60, 0x3db8aa3b
    s_mov_b32 s61, s60
    s_mov_b32 s7, 4194304
L_spin_41:
    ds_read_b32 v7, v5 offset:16
    s_sub_u32 s7, s7, 1
    s_cbranch_scc1 L_end
    s_waitcnt lgkmcnt(0)
    v_cmp_gt_u32 vcc, 4, v7
    s_cbranch_vccz L_spind_42
    s_sleep 1
    s_branch L_spin_41
L_spind_42:
    s_mov_b32 s7, 4194304
L_spin_43:
    ds_read_b32 v7, v5 offset:0
    s_sub_u32 s7, s7, 1
    s_cbranch_scc1 L_end
    s_waitcnt lgkmcnt(0)
    v_cmp_gt_u32 vcc, 0x62, v7
    s_cbranch_vccz L_spind_44
    s_sleep 1
    s_branch L_spin_43
L_spind_44:
    s_mov_b32 s7, 4194304
    buffer_load_dwordx4 v[64:67], v48, s[36:39], s57 offen offset:0 sc1
    buffer_load_dwordx4 v[68:71], v48, s[36:39], s57 offen offset:1024 sc1
    buffer_load_dwordx4 v[72:75], v48, s[36:39], s58 offen offset:0 sc1
    buffer_load_dwordx4 v[76:79], v48, s[36:39], s58 offen offset:1024 sc1
    s_sleep 12
L_pp_45:
    buffer_load_dwordx4 v[80:83], v48, s[36:39], s57 offen offset:0 sc1
    buffer_load_dwordx4 v[84:87], v48, s[36:39], s57 offen offset:1024 sc1
    buffer_load_dwordx4 v[88:91], v48, s[36:39], s58 offen offset:0 sc1
    buffer_load_dwordx4 v[92:95], v48, s[36:39], s58 offen offset:1024 sc1
    s_sub_u32 s7, s7, 1
    s_cbranch_scc1 L_end
    s_waitcnt vmcnt(4)
    v_xor_b32 v32, s48, v64
    v_xor_b32 v33, s49, v65
    v_xor_b32 v34, s50, v66
    v_xor_b32 v35, s51, v67
    v_xor_b32 v36, s48, v68
    v_xor_b32 v37, s49, v69
    v_xor_b32 v38, s50, v70
    v_xor_b32 v39, s51, v71
    v_xor_b32 v40, s48, v72
    v_xor_b32 v41, s49, v73
    v_xor_b32 v42, s50, v74
    v_xor_b32 v43, s51, v75
    v_xor_b32 v44, s48, v76
    v_xor_b32 v45, s49, v77
    v_xor_b32 v46, s50, v78
    v_xor_b32 v47, s51, v79
    v_or3_b32 v24, v32, v33, v34
    v_or3_b32 v24, v24, v35, v36
    v_or3_b32 v24, v24, v37, v38
    v_or3_b32 v24, v24, v39, v40
    v_or3_b32 v24, v24, v41, v42
    v_or3_b32 v24, v24, v43, v44
    v_or3_b32 v24, v24, v45, v46
    v_or_b32 v24, v24, v47
    v_and_b32 v24, v4, v24
    v_cmp_ne_u32 vcc, 0, v24
    s_cbranch_vccz L_ppd_46
    buffer_load_dwordx4 v[64:67], v48, s[36:39], s57 offen offset:0 sc1
    buffer_load_dwordx4 v[68:71], v48, s[36:39], s57 offen offset:1024 sc1
    buffer_load_dwordx4 v[72:75], v48, s[36:39], s58 offen offset:0 sc1
    buffer_load_dwordx4 v[76:79], v48, s[36:39], s58 offen offset:1024 sc1
    s_sub_u32 s7, s7, 1
    s_cbranch_scc1 L_end
    s_waitcnt vmcnt(4)
    v_xor_b32 v32, s48, v80
    v_xor_b32 v33, s49, v81
    v_xor_b32 v34, s50, v82
    v_xor_b32 v35, s51, v83
    v_xor_b32 v36, s48, v84
    v_xor_b32 v37, s49, v85
    v_xor_b32 v38, s50, v86
    v_xor_b32 v39, s51, v87
    v_xor_b32 v40, s48, v88
    v_xor_b32 v41, s49, v89
    v_xor_b32 v42, s50, v90
    v_xor_b32 v43, s51, v91
    v_xor_b32 v44, s48, v92
    v_xor_b32 v45, s49, v93
    v_xor_b32 v46, s50, v94
    v_xor_b32 v47, s51, v95
    v_or3_b32 v24, v32, v33, v34
    v_or3_b32 v24, v24, v35, v36
    v_or3_b32 v24, v24, v37, v38
    v_or3_b32 v24, v24, v39, v40
    v_or3_b32 v24, v24, v41, v42
    v_or3_b32 v24, v24, v43, v44
    v_or3_b32 v24, v24, v45, v46
    v_or_b32 v24, v24, v47
    v_and_b32 v24, v4, v24
    v_cmp_ne_u32 vcc, 0, v24
    s_cbranch_vccnz L_pp_45
L_ppd_46:
    v_max3_f32 v24, v32, v33, v34
    v_max3_f32 v25, v35, v36, v37
    v_max3_f32 v26, v38, v39, v40
    v_max3_f32 v27, v41, v42, v43
    v_max3_f32 v28, v44, v45, v46
    v_max3_f32 v24, v24, v25, v47
    v_max3_f32 v26, v26, v27, v28
    v_max_f32 v24, v24, v26
    s_nop 1
    v_max_f32_dpp v24, v24, v24 row_shr:1 row_mask:0xf bank_mask:0xf
    s_nop 1
    v_max_f32_dpp v24, v24, v24 row_shr:2 row_mask:0xf bank_mask:0xf
    s_nop 1
    v_max_f32_dpp v24, v24, v24 row_shr:4 row_mask:0xf bank_mask:0xf
    s_nop 1
    v_max_f32_dpp v24, v24, v24 row_shr:8 row_mask:0xf bank_mask:0xf
    s_nop 1
    v_max_f32_dpp v24, v24, v24 row_bcast:15 row_mask:0xa bank_mask:0xf
    s_nop 1
    v_max_f32_dpp v24, v24, v24 row_bcast:31 row_mask:0xc bank_mask:0xf
    s_nop 0
    v_readlane_b32 s62, v24, 63
    s_mov_b32 s63, s62
    s_nop 0
    v_pk_add_f32 v[32:33], v[32:33], s[62:63] neg_lo:[0,1] neg_hi:[0,1]
    v_pk_add_f32 v[34:35], v[34:35], s[62:63] neg_lo:[0,1] neg_hi:[0,1]
    v_pk_add_f32 v[36:37], v[36:37], s[62:63] neg_lo:[0,1] neg_hi:[0,1]
    v_pk_add_f32 v[38:39], v[38:39], s[62:63] neg_lo:[0,1] neg_hi:[0,1]
    v_pk_add_f32 v[40:41], v[40:41], s[62:63] neg_lo:[0,1] neg_hi:[0,1]
    v_pk_add_f32 v[42:43], v[42:43], s[62:63] neg_lo:[0,1] neg_hi:[0,1]
    v_pk_add_f32 v[44:45], v[44:45], s[62:63] neg_lo:[0,1] neg_hi:[0,1]
    v_pk_add_f32 v[46:47], v[46:47], s[62:63] neg_lo:[0,1] neg_hi:[0,1]
    v_pk_mul_f32 v[32:33], v[32:33], s[60:61]
    v_pk_mul_f32 v[34:35], v[34:35], s[60:61]
    v_pk_mul_f32 v[36:37], v[36:37], s[60:61]
    v_pk_mul_f32 v[38:39], v[38:39], s[60:61]
    v_pk_mul_f32 v[40:41], v[40:41], s[60:61]
    v_pk_mul_f32 v[42:43], v[42:43], s[60:61]
    v_pk_mul_f32 v[44:45], v[44:45], s[60:61]
    v_pk_mul_f32 v[46:47], v[46:47], s[60:61]
    v_exp_f32 v32, v32
    v_exp_f32 v33, v33
    v_exp_f32 v34, v34
    v_exp_f32 v35, v35
    v_exp_f32 v36, v36
    v_exp_f32 v37, v37
    v_exp_f32 v38, v38
    v_exp_f32 v39, v39
    v_exp_f32 v40, v40
    v_exp_f32 v41, v41
    v_exp_f32 v42, v42
    v_exp_f32 v43, v43
    v_exp_f32 v44, v44
    v_exp_f32 v45, v45
    v_exp_f32 v46, v46
    v_exp_f32 v47, v47
    v_pk_add_f32 v[24:25], v[32:33], v[34:35]
    v_pk_add_f32 v[26:27], v[36:37], v[38:39]
    v_pk_add_f32 v[28:29], v[40:41], v[42:43]
    v_pk_add_f32 v[30:31], v[44:45], v[46:47]
    v_pk_add_f32 v[24:25], v[24:25], v[26:27]
    v_pk_add_f32 v[28:29], v[28:29], v[30:31]
    v_pk_add_f32 v[24:25], v[24:25], v[28:29]
    v_add_f32 v24, v24, v25
    s_nop 1
    v_add_f32_dpp v24, v24, v24 row_shr:1 row_mask:0xf bank_mask:0xf
    s_nop 1
    v_add_f32_dpp v24, v24, v24 row_shr:2 row_mask:0xf bank_mask:0xf
    s_nop 1
    v_add_f32_dpp v24, v24, v24 row_shr:4 row_mask:0xf bank_mask:0xf
    s_nop 1
    v_add_f32_dpp v24, v24, v24 row_shr:8 row_mask:0xf bank_mask:0xf
    s_nop 1
    v_add_f32_dpp v24, v24, v24 row_bcast:15 row_mask:0xa bank_mask:0xf
    s_nop 1
    v_add_f32_dpp v24, v24, v24 row_bcast:31 row_mask:0xc bank_mask:0xf
    s_nop 0
    v_readlane_b32 s62, v24, 63
    s_nop 1
    v_rcp_f32 v24, s62
    s_nop 0
    v_pk_mul_f32 v[32:33], v[32:33], v[24:25] op_sel_hi:[1,0]
    v_pk_mul_f32 v[34:35], v[34:35], v[24:25] op_sel_hi:[1,0]
    v_pk_mul_f32 v[36:37], v[36:37], v[24:25] op_sel_hi:[1,0]
    v_pk_mul_f32 v[38:39], v[38:39], v[24:25] op_sel_hi:[1,0]
    v_cvt_pk_bf16_f32 v26, v32, v33
    v_cvt_pk_bf16_f32 v27, v34, v35
    v_cvt_pk_bf16_f32 v28, v36, v37
    v_cvt_pk_bf16_f32 v29, v38, v39
    ds_write_b64 v49, v[26:27]
    ds_write_b64 v49, v[28:29] offset:512
    s_mov_b64 exec, 1
    ds_add_u32 v5, v6 offset:20
    s_mov_b64 exec, -1
    s_add_u32 s34, s34, 0x9E3779B9
    s_and_b32 s48, s34, 0xff
    s_bfe_u32 s49, s34, 0x80008
    s_bfe_u32 s50, s34, 0x80010
    s_lshr_b32 s51, s34, 24
    s_waitcnt vmcnt(0)
L_tail:
    s_mov_b32 s7, 4194304
L_spin_47:
    ds_read_b32 v7, v5 offset:8
    s_sub_u32 s7, s7, 1
    s_cbranch_scc1 L_end
    s_waitcnt lgkmcnt(0)
    v_cmp_gt_u32 vcc, 1, v7
    s_cbranch_vccz L_spind_48
    s_sleep 1
    s_branch L_spin_47
L_spind_48:
    v_readfirstlane_b32 s42, v7
L_tail2:
    s_cmp_eq_u32 s43, 1
    s_cbranch_scc1 L_wo
    s_cmp_eq_u32 s43, 0
    s_cbranch_scc1 L_fin
    s_cmp_eq_u32 s43, 3
    s_cbranch_scc1 L_final
    v_mul_f32 v23, 0x3b124925, v23
    v_mov_b32 v30, 0x3b124925
    v_mov_b32 v31, 0xffff0000
    v_mov_b32 v29, 0xbdd2d3e8
    s_mov_b32 s60, 0x3f803f80
    v_mov_b32 v53, 0
    v_mov_b32 v56, 0
    v_mov_b32 v57, 0
    s_add_u32 s52, s10, 65536
    s_add_u32 s53, s11, 65536
    s_mov_b32 s7, 4194304
L_spin_49:
    ds_read_b32 v7, v5 offset:0
    s_sub_u32 s7, s7, 1
    s_cbranch_scc1 L_end
    s_waitcnt lgkmcnt(0)
    v_cmp_gt_u32 vcc, 0x92, v7
    s_cbranch_vccz L_spind_50
    s_sleep 2
    s_branch L_spin_49
L_spind_50:
    global_load_ushort v11, v11, s[22:23]
    ds_read_u16 v10, v10 offset:21120
    buffer_load_dword v0, v20, s[36:39], s12 offen
    s_mov_b32 s61, 0x3727c5ac
    v_mov_b32 v152, s60
    v_mov_b32 v153, s60
    v_mov_b32 v154, s60
    v_mov_b32 v155, s60
    v_mov_b32 v156, s60
    v_mov_b32 v157, s60
    v_mov_b32 v158, s60
    v_mov_b32 v159, s60
    v_mov_b32 v160, s60
    v_mov_b32 v161, s60
    v_mov_b32 v162, s60
    v_mov_b32 v163, s60
    v_mov_b32 v164, s60
    v_mov_b32 v165, s60
    v_mov_b32 v166, s60
    v_mov_b32 v167, s60
    s_mov_b32 s7, 4194304
L_spin_51:
    ds_read_b32 v7, v5 offset:0
    s_sub_u32 s7, s7, 1
    s_cbranch_scc1 L_end
    s_waitcnt lgkmcnt(0)
    v_cmp_gt_u32 vcc, 0xd4, v7
    s_cbranch_vccz L_spind_52
    s_sleep 1
    s_branch L_spin_51
L_spind_52:
    s_waitcnt vmcnt(0)
    v_lshlrev_b32 v10, 16, v10
    v_lshlrev_b32 v11, 16, v11
    s_mov_b32 s7, 4194304
L_poll_53:
    buffer_load_dwordx4 v[32:35], v12, s[36:39], s10 offen sc1
    buffer_load_dwordx4 v[36:39], v13, s[36:39], s11 offen sc1
    buffer_load_dwordx4 v[40:43], v12, s[36:39], s52 offen sc1
    buffer_load_dwordx4 v[44:47], v13, s[36:39], s53 offen sc1
    s_bitcmp1_b32 s35, 0
    s_cbranch_scc1 L_w1done
    ds_read_b64_tr_b16 v[64:65], v14 offset:0
    ds_read_b64_tr_b16 v[66:67], v14 offset:2048
    ds_read_b64_tr_b16 v[68:69], v14 offset:4096
    ds_read_b64_tr_b16 v[70:71], v14 offset:6144
    ds_read_b64_tr_b16 v[72:73], v14 offset:8192
    ds_read_b64_tr_b16 v[74:75], v14 offset:10240
    ds_read_b64_tr_b16 v[76:77], v14 offset:12288
    ds_read_b64_tr_b16 v[78:79], v14 offset:14336
    ds_read_b64_tr_b16 v[80:81], v14 offset:16384
    ds_read_b64_tr_b16 v[82:83], v14 offset:18432
    ds_read_b64_tr_b16 v[84:85], v14 offset:20480
    ds_read_b64_tr_b16 v[86:87], v14 offset:22528
    ds_read_b64_tr_b16 v[88:89], v14 offset:24576
    ds_read_b64_tr_b16 v[90:91], v14 offset:26624
    ds_read_b64_tr_b16 v[92:93], v14 offset:28672
    ds_read_b64_tr_b16 v[94:95], v14 offset:30720
    ds_read_b64_tr_b16 v[96:97], v14 offset:32768
    ds_read_b64_tr_b16 v[98:99], v14 offset:34816
    ds_read_b64_tr_b16 v[100:101], v14 offset:36864
    ds_read_b64_tr_b16 v[102:103], v14 offset:38912
    ds_read_b64_tr_b16 v[104:105], v14 offset:40960
    ds_read_b64_tr_b16 v[106:107], v14 offset:43008
    ds_read_b64_tr_b16 v[108:109], v14 offset:45056
    ds_read_b64_tr_b16 v[110:111], v14 offset:47104
    ds_read_b64_tr_b16 v[112:113], v14 offset:49152
    ds_read_b64_tr_b16 v[114:115], v14 offset:51200
    ds_read_b64_tr_b16 v[116:117], v14 offset:53248
    ds_read_b64_tr_b16 v[118:119], v14 offset:55296
    s_bitset1_b32 s35, 0
L_w1done:
    s_bitcmp1_b32 s35, 1
    s_cbranch_scc1 L_try_54
    ds_read_b32 v24, v5 offset:36
    s_waitcnt lgkmcnt(0)
    v_cmp_gt_u32 vcc, 0x1, v24
    s_cbranch_vccnz L_try_54
    ds_read_b64_tr_b16 v[120:121], v15 offset:0
    ds_read_b64_tr_b16 v[122:123], v15 offset:2048
    ds_read_b64_tr_b16 v[124:125], v15 offset:4096
    ds_read_b64_tr_b16 v[126:127], v15 offset:6144
    ds_read_b64_tr_b16 v[128:129], v16 offset:0
    ds_read_b64_tr_b16 v[130:131], v16 offset:2048
    ds_read_b64_tr_b16 v[132:133], v16 offset:4096
    ds_read_b64_tr_b16 v[134:135], v16 offset:6144
    ds_read_b64_tr_b16 v[136:137], v17 offset:0
    ds_read_b64_tr_b16 v[138:139], v17 offset:2048
    ds_read_b64_tr_b16 v[140:141], v17 offset:4096
    ds_read_b64_tr_b16 v[142:143], v17 offset:6144
    ds_read_b64_tr_b16 v[144:145], v18 offset:0
    ds_read_b64_tr_b16 v[146:147], v18 offset:2048
    ds_read_b64_tr_b16 v[148:149], v18 offset:4096
    ds_read_b64_tr_b16 v[150:151], v18 offset:6144
    s_bitset1_b32 s35, 1
L_try_54:
    s_sub_u32 s7, s7, 1
    s_cbranch_scc1 L_end
    s_waitcnt vmcnt(0)
    v_xor_b32 v32, s48, v32
    v_xor_b32 v33, s49, v33
    v_xor_b32 v34, s50, v34
    v_xor_b32 v35, s51, v35
    v_xor_b32 v36, s48, v36
    v_xor_b32 v37, s49, v37
    v_xor_b32 v38, s50, v38
    v_xor_b32 v39, s51, v39
    v_xor_b32 v40, s48, v40
    v_xor_b32 v41, s49, v41
    v_xor_b32 v42, s50, v42
    v_xor_b32 v43, s51, v43
    v_xor_b32 v44, s48, v44
    v_xor_b32 v45, s49, v45
    v_xor_b32 v46, s50, v46
    v_xor_b32 v47, s51, v47
    v_or3_b32 v24, v32, v33, v34
    v_or3_b32 v24, v24, v35, v36
    v_or3_b32 v24, v24, v37, v38
    v_or3_b32 v24, v24, v39, v40
    v_or3_b32 v24, v24, v41, v42
    v_or3_b32 v24, v24, v43, v44
    v_or3_b32 v24, v24, v45, v46
    v_or_b32 v24, v24, v47
    v_and_b32 v24, v4, v24
    v_cmp_ne_u32 vcc, 0, v24
    s_cbranch_vccnz L_poll_53
    v_pk_add_f32 v[32:33], v[32:33], v[36:37]
    v_pk_add_f32 v[34:35], v[34:35], v[38:39]
    v_pk_add_f32 v[40:41], v[40:41], v[44:45]
    v_pk_add_f32 v[42:43], v[42:43], v[46:47]
    v_pk_add_f32 v[32:33], v[32:33], v[40:41]
    v_pk_add_f32 v[34:35], v[34:35], v[42:43]
    s_nop 0
    v_permlane32_swap_b32 v32, v33
    v_permlane32_swap_b32 v34, v35
    v_add_f32 v32, v32, v33
    v_add_f32 v34, v34, v35
    s_nop 1
    v_permlane16_swap_b32 v32, v34
    v_add_f32 v32, v32, v34
    v_cvt_pk_bf16_f32 v32, 0, v32
    v_add_f32 v32, v10, v32
    v_cvt_pk_bf16_f32 v32, v32, v32
    ds_write_b16 v8, v32 offset:29312
    s_mov_b64 exec, 1
    ds_add_u32 v5, v6 offset:32
    s_mov_b64 exec, -1
    s_cmp_lt_u32 s3, 4
    s_cbranch_scc1 L_m_ln
    s_call_b64 s[44:45], L_fsetup
    s_or_b32 s6, s40, s41
    s_xor_b32 s7, s3, 4
    s_or_b32 s6, s6, s7
    s_cbranch_scc1 L_m_bar2
    v_mov_b32 v33, s34
    s_mov_b64 exec, 1
    buffer_store_dword v33, v5, s[36:39], 0 offen sc1
    s_mov_b64 exec, -1
    s_branch L_m_bar2
L_m_ln:
    s_mov_b32 s7, 4194304
L_spin_55:
    ds_read_b32 v7, v5 offset:32
    ds_read_b128 v[24:27], v19 offset:29312
    s_sub_u32 s7, s7, 1
    s_cbranch_scc1 L_end
    s_waitcnt lgkmcnt(0)
    v_cmp_gt_u32 vcc, 7, v7
    s_cbranch_vccnz L_spin_55
    v_dot2_f32_bf16 v48, v24, s60, 0
    v_dot2_f32_bf16 v48, v25, s60, v48
    v_dot2_f32_bf16 v48, v26, s60, v48
    v_dot2_f32_bf16 v48, v27, s60, v48
    v_lshlrev_b32 v32, 16, v24
    v_and_b32 v33, v31, v24
    v_lshlrev_b32 v34, 16, v25
    v_add_f32_dpp v48, v48, v48 row_shr:1 row_mask:0xf bank_mask:0xf
    v_and_b32 v35, v31, v25
    v_lshlrev_b32 v36, 16, v26
    v_add_f32_dpp v48, v48, v48 row_shr:2 row_mask:0xf bank_mask:0xf
    v_and_b32 v37, v31, v26
    v_lshlrev_b32 v38, 16, v27
    v_add_f32_dpp v48, v48, v48 row_shr:4 row_mask:0xf bank_mask:0xf
    v_and_b32 v39, v31, v27
    s_nop 0
    v_add_f32_dpp v48, v48, v48 row_shr:8 row_mask:0xf bank_mask:0xf
    s_nop 1
    v_add_f32_dpp v48, v48, v48 row_bcast:15 row_mask:0xa bank_mask:0xf
    s_nop 1
    v_add_f32_dpp v48, v48, v48 row_bcast:31 row_mask:0xc bank_mask:0xf
    s_nop 0
    v_readlane_b32 s62, v48, 63
    s_nop 1
    v_mul_f32 v48, s62, v23
    v_pk_add_f32 v[40:41], v[32:33], v[48:49] op_sel_hi:[1,0] neg_lo:[0,1] neg_hi:[0,1]
    v_pk_add_f32 v[42:43], v[34:35], v[48:49] op_sel_hi:[1,0] neg_lo:[0,1] neg_hi:[0,1]
    v_pk_add_f32 v[44:45], v[36:37], v[48:49] op_sel_hi:[1,0] neg_lo:[0,1] neg_hi:[0,1]
    v_pk_add_f32 v[46:47], v[38:39], v[48:49] op_sel_hi:[1,0] neg_lo:[0,1] neg_hi:[0,1]
    v_cvt_pk_bf16_f32 v24, v40, v41
    v_cvt_pk_bf16_f32 v25, v42, v43
    v_cvt_pk_bf16_f32 v26, v44, v45
    v_cvt_pk_bf16_f32 v27, v46, v47
    v_mov_b64_dpp v[152:153], v[24:25] row_newbcast:0 row_mask:0xf bank_mask:0x3
    s_nop 0
    v_mov_b64_dpp v[154:155], v[26:27] row_newbcast:0 row_mask:0xf bank_mask:0x3
    v_mov_b64_dpp v[156:157], v[24:25] row_newbcast:1 row_mask:0xf bank_mask:0x3
    v_mov_b64_dpp v[158:159], v[26:27] row_newbcast:1 row_mask:0xf bank_mask:0x3
    v_mfma_f32_16x16x32_bf16 v[32:35], v[64:67], v[152:155], 0
    v_mov_b64_dpp v[160:161], v[24:25] row_newbcast:2 row_mask:0xf bank_mask:0x3
    v_mov_b64_dpp v[162:163], v[26:27] row_newbcast:2 row_mask:0xf bank_mask:0x3
    v_dot2_f32_bf16 v48, v24, s60, 0
    v_dot2_f32_bf16 v49, v24, v24, 0
    v_mfma_f32_16x16x32_bf16 v[32:35], v[68:71], v[156:159], v[32:35]
    v_mov_b64_dpp v[164:165], v[24:25] row_newbcast:3 row_mask:0xf bank_mask:0x3
    v_mov_b64_dpp v[166:167], v[26:27] row_newbcast:3 row_mask:0xf bank_mask:0x3
    v_dot2_f32_bf16 v48, v25, s60, v48
    v_dot2_f32_bf16 v49, v25, v25, v49
    v_mfma_f32_16x16x32_bf16 v[32:35], v[72:75], v[160:163], v[32:35]
    v_mov_b64_dpp v[152:153], v[24:25] row_newbcast:4 row_mask:0xf bank_mask:0x3
    v_mov_b64_dpp v[154:155], v[26:27] row_newbcast:4 row_mask:0xf bank_mask:0x3
    v_dot2_f32_bf16 v48, v26, s60, v48
    v_dot2_f32_bf16 v49, v26, v26, v49
    v_mfma_f32_16x16x32_bf16 v[32:35], v[76:79], v[164:167], v[32:35]
    v_mov_b64_dpp v[156:157], v[24:25] row_newbcast:5 row_mask:0xf bank_mask:0x3
    v_mov_b64_dpp v[158:159], v[26:27] row_newbcast:5 row_mask:0xf bank_mask:0x3
    v_dot2_f32_bf16 v48, v27, s60, v48
    v_dot2_f32_bf16 v49, v27, v27, v49
    v_mfma_f32_16x16x32_bf16 v[32:35], v[80:83], v[152:155], v[32:35]
    v_mov_b64_dpp v[160:161], v[24:25] row_newbcast:6 row_mask:0xf bank_mask:0x3
    v_mov_b64_dpp v[162:163], v[26:27] row_newbcast:6 row_mask:0xf bank_mask:0x3
    v_add_f32_dpp v48, v48, v48 row_shr:1 row_mask:0xf bank_mask:0xf
    v_add_f32_dpp v49, v49, v49 row_shr:1 row_mask:0xf bank_mask:0xf
    v_mfma_f32_16x16x32_bf16 v[32:35], v[84:87], v[156:159], v[32:35]
    v_mov_b64_dpp v[164:165], v[24:25] row_newbcast:7 row_mask:0xf bank_mask:0x3
    v_mov_b64_dpp v[166:167], v[26:27] row_newbcast:7 row_mask:0xf bank_mask:0x3
    v_add_f32_dpp v48, v48, v48 row_shr:2 row_mask:0xf bank_mask:0xf
    v_add_f32_dpp v49, v49, v49 row_shr:2 row_mask:0xf bank_mask:0xf
    v_mfma_f32_16x16x32_bf16 v[32:35], v[88:91], v[160:163], v[32:35]
    v_mov_b64_dpp v[152:153], v[24:25] row_newbcast:8 row_mask:0xf bank_mask:0x3
    v_mov_b64_dpp v[154:155], v[26:27] row_newbcast:8 row_mask:0xf bank_mask:0x3
    v_add_f32_dpp v48, v48, v48 row_shr:4 row_mask:0xf bank_mask:0xf
    v_add_f32_dpp v49, v49, v49 row_shr:4 row_mask:0xf bank_mask:0xf
    v_mfma_f32_16x16x32_bf16 v[32:35], v[92:95], v[164:167], v[32:35]
    v_mov_b64_dpp v[156:157], v[24:25] row_newbcast:9 row_mask:0xf bank_mask:0x3
    v_mov_b64_dpp v[158:159], v[26:27] row_newbcast:9 row_mask:0xf bank_mask:0x3
    v_add_f32_dpp v48, v48, v48 row_shr:8 row_mask:0xf bank_mask:0xf
    v_add_f32_dpp v49, v49, v49 row_shr:8 row_mask:0xf bank_mask:0xf
    v_mfma_f32_16x16x32_bf16 v[32:35], v[96:99], v[152:155], v[32:35]
    v_mov_b64_dpp v[160:161], v[24:25] row_newbcast:10 row_mask:0xf bank_mask:0x3
    v_mov_b64_dpp v[162:163], v[26:27] row_newbcast:10 row_mask:0xf bank_mask:0x3
    v_add_f32_dpp v48, v48, v48 row_bcast:15 row_mask:0xa bank_mask:0xf
    v_add_f32_dpp v49, v49, v49 row_bcast:15 row_mask:0xa bank_mask:0xf
    v_mfma_f32_16x16x32_bf16 v[32:35], v[100:103], v[156:159], v[32:35]
    v_mov_b64_dpp v[164:165], v[24:25] row_newbcast:11 row_mask:0xf bank_mask:0x3
    v_mov_b64_dpp v[166:167], v[26:27] row_newbcast:11 row_mask:0xf bank_mask:0x3
    v_add_f32_dpp v48, v48, v48 row_bcast:31 row_mask:0xc bank_mask:0xf
    v_add_f32_dpp v49, v49, v49 row_bcast:31 row_mask:0xc bank_mask:0xf
    v_mfma_f32_16x16x32_bf16 v[32:35], v[104:107], v[160:163], v[32:35]
    v_mov_b64_dpp v[152:153], v[24:25] row_newbcast:12 row_mask:0xf bank_mask:0x3
    v_mov_b64_dpp v[154:155], v[26:27] row_newbcast:12 row_mask:0xf bank_mask:0x3
    v_readlane_b32 s62, v48, 63
    v_readlane_b32 s63, v49, 63
    v_mfma_f32_16x16x32_bf16 v[32:35], v[108:111], v[164:167], v[32:35]
    v_mov_b64_dpp v[156:157], v[24:25] row_newbcast:13 row_mask:0xf bank_mask:0x3
    v_mov_b64_dpp v[158:159], v[26:27] row_newbcast:13 row_mask:0xf bank_mask:0x3
    v_mul_f32 v48, s62, v30
    v_mul_f32 v49, s63, v30
    v_mfma_f32_16x16x32_bf16 v[32:35], v[112:115], v[152:155], v[32:35]
    v_fma_f32 v49, -v48, v48, v49
    v_add_f32 v50, s61, v49
    v_mfma_f32_16x16x32_bf16 v[32:35], v[116:119], v[156:159], v[32:35]
    v_rsq_f32 v50, v50
    v_sub_f32 v48, 0, v48
    v_mul_f32 v51, v50, v50
    v_fma_f32 v51, v51, v49, s61
    v_rsq_f32 v51, v51
    s_nop 2
    v_cndmask_b32 v32, v32, v33, s[14:15]
    v_cndmask_b32 v34, v34, v35, s[14:15]
    v_cndmask_b32 v32, v32, v34, s[16:17]
    v_mul_f32 v49, v50, v51
    s_nop 0
    v_fmac_f32_dpp v32, v32, v48 row_ror:8 row_mask:0xf bank_mask:0x3
    v_fma_f32 v32, v32, v49, v11
    v_mul_f32 v33, v32, v32
    v_fmaak_f32 v33, v29, v33, 0xc0135761
    v_mul_f32 v33, v32, v33
    v_exp_f32 v33, v33
    s_nop 0
    v_add_f32 v33, 1.0, v33
    v_rcp_f32 v33, v33
    s_nop 0
    v_mul_f32 v32, v32, v33
    v_cvt_pk_bf16_f32 v32, v32, v32
    ds_write_b16 v9, v32 offset:30464
L_m_bar2:
    s_bitcmp1_b32 s35, 1
    s_cbranch_scc1 L_must_56
    s_mov_b32 s7, 4194304
L_spin_57:
    ds_read_b32 v7, v5 offset:36
    s_sub_u32 s7, s7, 1
    s_cbranch_scc1 L_end
    s_waitcnt lgkmcnt(0)
    v_cmp_gt_u32 vcc, 0x1, v7
    s_cbranch_vccnz L_spin_57
    ds_read_b64_tr_b16 v[120:121], v15 offset:0
    ds_read_b64_tr_b16 v[122:123], v15 offset:2048
    ds_read_b64_tr_b16 v[124:125], v15 offset:4096
    ds_read_b64_tr_b16 v[126:127], v15 offset:6144
    ds_read_b64_tr_b16 v[128:129], v16 offset:0
    ds_read_b64_tr_b16 v[130:131], v16 offset:2048
    ds_read_b64_tr_b16 v[132:133], v16 offset:4096
    ds_read_b64_tr_b16 v[134:135], v16 offset:6144
    ds_read_b64_tr_b16 v[136:137], v17 offset:0
    ds_read_b64_tr_b16 v[138:139], v17 offset:2048
    ds_read_b64_tr_b16 v[140:141], v17 offset:4096
    ds_read_b64_tr_b16 v[142:143], v17 offset:6144
    ds_read_b64_tr_b16 v[144:145], v18 offset:0
    ds_read_b64_tr_b16 v[146:147], v18 offset:2048
    ds_read_b64_tr_b16 v[148:149], v18 offset:4096
    ds_read_b64_tr_b16 v[150:151], v18 offset:6144
L_must_56:
    s_waitcnt lgkmcnt(0)
    s_barrier
    ds_read_b128 v[24:27], v22 offset:30464
    ds_read_b128 v[48:51], v22 offset:30528
    s_waitcnt lgkmcnt(1)
    v_mfma_f32_16x16x32_bf16 v[32:35], v[120:123], v[24:27], 0
    v_mfma_f32_16x16x32_bf16 v[36:39], v[128:131], v[24:27], 0
    s_waitcnt lgkmcnt(0)
    v_mfma_f32_16x16x32_bf16 v[32:35], v[124:127], v[48:51], v[32:35]
    v_mfma_f32_16x16x32_bf16 v[36:39], v[132:135], v[48:51], v[36:39]
    v_mfma_f32_16x16x32_bf16 v[40:43], v[136:139], v[24:27], 0
    v_mfma_f32_16x16x32_bf16 v[44:47], v[144:147], v[24:27], 0
    v_mfma_f32_16x16x32_bf16 v[40:43], v[140:143], v[48:51], v[40:43]
    v_mfma_f32_16x16x32_bf16 v[44:47], v[148:151], v[48:51], v[44:47]
    s_nop 2
    v_cndmask_b32 v32, v32, v33, s[14:15]
    v_cndmask_b32 v34, v34, v35, s[14:15]
    v_cndmask_b32 v32, v32, v34, s[16:17]
    v_cndmask_b32 v36, v36, v37, s[14:15]
    v_cndmask_b32 v38, v38, v39, s[14:15]
    v_cndmask_b32 v36, v36, v38, s[16:17]
    v_cndmask_b32 v32, v32, v36, s[18:19]
    v_cndmask_b32 v40, v40, v41, s[14:15]
    v_cndmask_b32 v42, v42, v43, s[14:15]
    v_cndmask_b32 v40, v40, v42, s[16:17]
    v_cndmask_b32 v44, v44, v45, s[14:15]
    v_cndmask_b32 v46, v46, v47, s[14:15]
    v_cndmask_b32 v44, v44, v46, s[16:17]
    v_cndmask_b32 v40, v40, v44, s[18:19]
    v_cndmask_b32 v32, v32, v40, s[20:21]
    v_bfi_b32 v32, v4, v21, v32
    buffer_store_dword v32, v20, s[36:39], s12 offen sc1
    s_cmp_lg_u32 s3, s4
    s_cbranch_scc1 L_m_pubd
    s_cmp_lg_u32 s42, 1
    s_cbranch_scc1 L_slow_58
    buffer_store_dword v32, v20, s[36:39], s13 offen
    s_branch L_pubd_59
L_slow_58:
    buffer_store_dword v32, v20, s[36:39], s13 offen sc1
L_pubd_59:
L_m_pubd:
    s_barrier
    s_cmp_lt_u32 s3, 4
    s_cbranch_scc1 L_fin
    s_branch L_fin_go
L_fsetup:
    v_and_b32 v52, 1, v3
    v_lshlrev_b32 v52, 1, v52
    v_lshrrev_b32 v53, 1, v3
    v_add_u32 v52, v52, v53
    s_min_u32 s58, s40, 6
    s_and_b32 s59, s3, 3
    v_and_b32 v53, 3, v2
    v_lshl_add_u32 v53, v53, 4, v52
    s_lshl_b32 s6, s58, 6
    v_add_u32 v53, s6, v53
    s_lshl_b32 s6, s59, 2
    v_add_u32 v53, s6, v53
    v_lshrrev_b32 v54, 5, v53
    v_lshlrev_b32 v54, 6, v54
    v_bfe_u32 v52, v53, 2, 2
    v_lshl_add_u32 v54, v52, 4, v54
    v_bfe_u32 v52, v53, 4, 1
    v_lshl_add_u32 v54, v52, 3, v54
    v_and_b32 v52, 3, v53
    v_lshl_add_u32 v54, v52, 1, v54
    v_lshlrev_b32 v53, 1, v53
    global_load_ushort v55, v53, s[26:27]
    v_lshrrev_b32 v56, 2, v1
    v_mul_u32_u24 v56, 7168, v56
    v_and_b32 v52, 3, v1
    v_lshl_add_u32 v56, v52, 4, v56
    s_mul_i32 s56, s41, 1792
    s_lshl_b32 s6, s58, 8
    s_add_u32 s56, s56, s6
    s_lshl_b32 s6, s59, 6
    s_add_u32 s56, s56, s6
    s_add_u32 s56, s56, 139264
    s_add_u32 s57, s56, 114688
    s_mul_i32 s6, s41, 896
    v_add_u32 v53, s6, v53
    s_lshl_b32 s7, s41, 3
    s_add_u32 s7, s7, s4
    s_lshl_b32 s7, s7, 13
    s_lshl_b32 s6, s59, 6
    s_add_u32 s7, s7, s6
    s_add_u32 s7, s7, 606208
    s_sub_u32 s7, s7, s56
    v_lshrrev_b32 v57, 5, v1
    v_lshlrev_b32 v57, 8, v57
    v_lshl_add_u32 v57, v52, 4, v57
    v_add_u32 v58, s7, v57
    v_bfe_u32 v52, v1, 2, 3
    v_cmp_eq_u32 vcc, s4, v52
    v_subrev_u32 v57, 114176, v58
    s_nop 0
    v_cndmask_b32 v57, v56, v57, vcc
    v_cndmask_b32 v56, v56, v58, vcc
    v_mov_b32 v68, s48
    v_mov_b32 v69, s49
    v_mov_b32 v70, s50
    v_mov_b32 v71, s51
    s_nop 4
    s_setpc_b64 s[44:45]
L_final:
    s_call_b64 s[44:45], L_fsetup
    s_barrier
    s_barrier
L_fin_go:
    s_cmp_ge_u32 s40, 7
    s_cbranch_scc1 L_fin
    ds_read_u16 v54, v54 offset:29312
    s_sleep 9
    s_mov_b32 s7, 4194304
L_pp_60:
    buffer_load_dwordx4 v[64:67], v56, s[36:39], s56 offen sc1
    s_mov_b32 exec_hi, 0xffff
    buffer_load_dwordx4 v[68:71], v57, s[36:39], s57 offen sc1
    s_mov_b32 exec_hi, -1
    s_sub_u32 s7, s7, 1
    s_cbranch_scc1 L_end
    s_waitcnt vmcnt(0)
    v_xor_b32 v32, s48, v64
    v_xor_b32 v33, s49, v65
    v_xor_b32 v34, s50, v66
    v_xor_b32 v35, s51, v67
    v_xor_b32 v36, s48, v68
    v_xor_b32 v37, s49, v69
    v_xor_b32 v38, s50, v70
    v_xor_b32 v39, s51, v71
    v_or3_b32 v24, v32, v33, v34
    v_or3_b32 v24, v24, v35, v36
    v_or3_b32 v24, v24, v37, v38
    v_or_b32 v24, v24, v39
    v_and_b32 v24, v4, v24
    v_cmp_ne_u32 vcc, 0, v24
    s_cbranch_vccnz L_pp_60
L_ppd_61:
    v_pk_add_f32 v[32:33], v[32:33], v[36:37]
    v_pk_add_f32 v[34:35], v[34:35], v[38:39]
    s_waitcnt lgkmcnt(0)
    v_permlane32_swap_b32 v32, v33
    v_permlane32_swap_b32 v34, v35
    v_add_f32 v32, v32, v33
    v_add_f32 v34, v34, v35
    v_lshlrev_b32 v54, 16, v54
    v_lshlrev_b32 v55, 16, v55
    v_permlane16_swap_b32 v32, v34
    v_add_f32 v32, v32, v34
    s_nop 1
    v_add_f32_dpp v32, v32, v32 row_ror:8 row_mask:0xf bank_mask:0xf
    s_nop 1
    v_add_f32_dpp v32, v32, v32 row_ror:4 row_mask:0xf bank_mask:0xf
    s_mov_b32 exec_lo, 0xf000f
    s_mov_b32 exec_hi, 0xf000f
    v_cvt_pk_bf16_f32 v32, 0, v32
    v_add_f32 v32, v55, v32
    v_cvt_pk_bf16_f32 v32, 0, v32
    v_add_f32 v32, v54, v32
    v_cvt_pk_bf16_f32 v32, v32, v32
    global_store_short v53, v32, s[28:29]
    s_mov_b64 exec, -1
    s_branch L_fin
L_setup:
    s_nop 1
    s_cmp_ge_u32 s3, 4
    s_cselect_b32 s35, 1, 0
    v_and_b32 v23, 3, v2
    v_lshlrev_b32 v21, 3, v23
    s_add_u32 s6, s34, 0x9E3779B9
    v_lshrrev_b32 v21, v21, s6
    v_and_b32 v22, 1, v2
    v_cmp_ne_u32 s[14:15], 0, v22
    v_cmp_lt_u32 s[16:17], 1, v23
    s_lshl_b32 s6, s3, 13
    s_add_u32 s6, s6, 32768
    v_lshrrev_b32 v14, 2, v2
    v_lshl_add_u32 v14, v3, 2, v14
    v_bfe_u32 v22, v14, 1, 2
    v_lshlrev_b32 v14, 7, v14
    v_lshl_add_u32 v14, v22, 5, v14
    v_and_b32 v22, 3, v2
    v_lshl_add_u32 v14, v22, 3, v14
    v_add_u32 v15, s6, v14
    v_xor_b32 v16, 32, v15
    v_xor_b32 v17, 64, v15
    v_xor_b32 v18, 0x60, v15
    s_lshl_b32 s6, s3, 5
    v_xor_b32 v14, s6, v14
    v_add_u32 v14, 98304, v14
    s_mov_b32 s43, 1
    s_and_b32 s40, s5, 7
    s_lshr_b32 s41, s5, 4
    s_add_u32 s6, s5, 8
    s_and_b32 s6, s6, 0x17
    s_cmp_lt_u32 s6, 7
    s_cbranch_scc1 L_set_wo
    s_mov_b32 s43, 0
    s_sub_u32 s6, s5, 8
    s_cmp_ge_u32 s6, 16
    s_cbranch_scc1 L_set_ret
    s_and_b32 s41, s6, 3
    s_lshr_b32 s6, s6, 2
    s_lshl_b32 s40, s6, 3
    s_add_u32 s40, s40, s4
    s_cmp_ge_u32 s40, 28
    s_cbranch_scc1 L_set_ret
    s_mov_b32 s43, 3
    s_cmp_eq_u32 s3, 7
    s_cbranch_scc1 L_set_ret
    s_mov_b32 s43, 2
    v_and_b32 v19, 1, v3
    v_lshlrev_b32 v19, 1, v19
    v_lshrrev_b32 v20, 1, v3
    v_add_u32 v19, v19, v20
    v_lshl_add_u32 v19, v2, 2, v19
    s_lshl_b32 s6, s3, 6
    v_add_u32 v19, s6, v19
    s_mul_i32 s6, s41, 896
    v_lshl_add_u32 v20, v19, 1, s6
    v_mov_b32 v10, v20
    v_lshrrev_b32 v8, 5, v19
    v_lshlrev_b32 v8, 6, v8
    v_bfe_u32 v20, v19, 2, 2
    v_lshl_add_u32 v8, v20, 4, v8
    v_bfe_u32 v20, v19, 4, 1
    v_lshl_add_u32 v8, v20, 3, v8
    v_and_b32 v20, 3, v19
    v_lshl_add_u32 v8, v20, 1, v8
    s_and_b32 s6, s3, 3
    s_lshl_b32 s6, s6, 4
    v_lshl_add_u32 v19, v3, 2, v23
    v_add_u32 v19, s6, v19
    s_lshl_b32 s6, s40, 7
    v_lshl_add_u32 v20, v19, 1, s6
    v_mov_b32 v11, v20
    v_lshrrev_b32 v9, 5, v19
    v_lshlrev_b32 v9, 6, v9
    v_bfe_u32 v20, v19, 2, 2
    v_lshl_add_u32 v9, v20, 4, v9
    v_bfe_u32 v20, v19, 4, 1
    v_lshl_add_u32 v9, v20, 3, v9
    v_and_b32 v20, 3, v19
    v_lshl_add_u32 v9, v20, 1, v9
    v_and_b32 v20, 8, v2
    v_lshl_add_u32 v9, v20, 4, v9
    v_mul_u32_u24 v12, 7168, v3
    v_lshl_add_u32 v12, v2, 4, v12
    v_mov_b32 v13, v12
    s_mul_i32 s13, s41, 14592
    s_lshl_b32 s6, s4, 11
    s_add_u32 s13, s13, s6
    s_add_u32 s13, s13, 466944
    v_lshl_add_u32 v19, v2, 4, s13
    v_cmp_eq_u32 vcc, s4, v3
    v_add_u32 v20, 4, v3
    s_nop 0
    v_cndmask_b32 v12, v12, v19, vcc
    v_cmp_eq_u32 vcc, s4, v20
    v_subrev_u32 v19, 28672, v19
    s_nop 0
    v_cndmask_b32 v13, v13, v19, vcc
    s_mul_i32 s10, s41, 1792
    s_lshl_b32 s6, s3, 8
    s_add_u32 s10, s10, s6
    s_add_u32 s12, s10, 139264
    s_add_u32 s10, s10, 8192
    s_add_u32 s11, s10, 28672
    s_mul_i32 s6, s40, 7168
    s_add_u32 s12, s12, s6
    s_lshl_b32 s13, s41, 3
    s_add_u32 s13, s13, s4
    s_lshl_b32 s13, s13, 13
    s_lshr_b32 s6, s40, 3
    s_lshl_b32 s6, s6, 8
    s_add_u32 s13, s13, s6
    s_add_u32 s13, s13, 606208
    v_lshlrev_b32 v22, 4, v3
    v_lshl_add_u32 v19, v2, 6, v22
    v_and_b32 v20, 4, v2
    v_cmp_ne_u32 s[18:19], 0, v20
    v_cmp_lt_u32 s[20:21], 7, v2
    v_cmp_gt_u32 vcc, 14, v2
    v_lshlrev_b32 v20, 2, v1
    s_nop 0
    v_cndmask_b32 v23, 0, 1.0, vcc
    s_branch L_set_touch
L_set_wo:
    v_lshrrev_b32 v8, 3, v1
    v_lshlrev_b32 v8, 14, v8
    v_and_b32 v19, 7, v1
    v_lshl_add_u32 v8, v19, 4, v8
    s_lshl_b32 s10, s4, 11
    s_lshl_b32 s6, s41, 10
    s_add_u32 s10, s10, s6
    s_lshl_b32 s6, s3, 7
    s_add_u32 s10, s10, s6
    s_add_u32 s10, s10, 344064
    v_bfe_u32 v9, v1, 3, 2
    v_lshlrev_b32 v9, 6, v9
    v_lshl_add_u32 v9, v23, 4, v9
    v_bfe_u32 v19, v1, 2, 1
    v_lshl_add_u32 v9, v19, 3, v9
    v_lshrrev_b32 v19, 5, v1
    v_lshl_add_u32 v9, v19, 2, v9
    s_lshl_b32 s6, s3, 8
    v_add_u32 v9, s6, v9
    v_lshrrev_b32 v19, 2, v2
    v_lshlrev_b32 v10, 6, v19
    v_lshl_add_u32 v10, v3, 4, v10
    v_mul_u32_u24 v20, 1792, v19
    v_lshl_add_u32 v20, v3, 4, v20
    v_lshl_add_u32 v20, v23, 2, v20
    v_lshlrev_b32 v11, 14, v19
    v_lshl_add_u32 v11, v3, 4, v11
    v_lshl_add_u32 v11, v23, 2, v11
    s_lshl_b32 s13, s41, 16
    s_lshl_b32 s6, s40, 8
    s_add_u32 s13, s13, s6
    s_and_b32 s6, s3, 3
    s_lshl_b32 s6, s6, 6
    s_add_u32 s13, s13, s6
    s_mul_i32 s12, s4, 7168
    s_add_u32 s12, s12, s13
    s_add_u32 s12, s12, 8192
    s_lshl_b32 s6, s4, 11
    s_add_u32 s13, s13, s6
    s_add_u32 s13, s13, 475136
    s_cmp_ge_u32 s3, 4
    s_cbranch_scc1 L_set_ret
L_set_touch:
L_set_ret:
    s_nop 4
    s_setpc_b64 s[44:45]
L_wo:
    s_cmp_ge_u32 s3, 4
    s_cbranch_scc1 L_wo_nt
    buffer_load_dword v0, v20, s[36:39], s12 offen
L_wo_nt:
    s_mov_b32 s7, 4194304
L_spin_62:
    ds_read_b32 v7, v5 offset:0
    s_sub_u32 s7, s7, 1
    s_cbranch_scc1 L_end
    s_waitcnt lgkmcnt(0)
    v_cmp_gt_u32 vcc, 0xaa, v7
    s_cbranch_vccz L_spind_63
    s_sleep 1
    s_branch L_spin_62
L_spind_63:
    s_mov_b32 s7, 4194304
L_poll_64:
    buffer_load_dwordx4 v[32:35], v8, s[36:39], s10 offen sc1
    s_bitcmp1_b32 s35, 0
    s_cbranch_scc1 L_try_65
    ds_read_b32 v24, v5 offset:0
    s_waitcnt lgkmcnt(0)
    v_cmp_gt_u32 vcc, 0xb2, v24
    s_cbranch_vccnz L_try_65
    ds_read_b64_tr_b16 v[40:41], v14 offset:0
    ds_read_b64_tr_b16 v[42:43], v14 offset:16384
    ds_read_b64_tr_b16 v[44:45], v14 offset:2048
    ds_read_b64_tr_b16 v[46:47], v14 offset:18432
    ds_read_b64_tr_b16 v[48:49], v14 offset:4096
    ds_read_b64_tr_b16 v[50:51], v14 offset:20480
    ds_read_b64_tr_b16 v[52:53], v14 offset:6144
    ds_read_b64_tr_b16 v[54:55], v14 offset:22528
    ds_read_b64_tr_b16 v[56:57], v14 offset:8192
    ds_read_b64_tr_b16 v[58:59], v14 offset:24576
    ds_read_b64_tr_b16 v[60:61], v14 offset:10240
    ds_read_b64_tr_b16 v[62:63], v14 offset:26624
    ds_read_b64_tr_b16 v[64:65], v14 offset:12288
    ds_read_b64_tr_b16 v[66:67], v14 offset:28672
    ds_read_b64_tr_b16 v[68:69], v14 offset:14336
    ds_read_b64_tr_b16 v[70:71], v14 offset:30720
    s_bitset1_b32 s35, 0
L_try_65:
    s_sub_u32 s7, s7, 1
    s_cbranch_scc1 L_end
    s_waitcnt vmcnt(0)
    v_xor_b32 v32, s48, v32
    v_xor_b32 v33, s49, v33
    v_xor_b32 v34, s50, v34
    v_xor_b32 v35, s51, v35
    v_or3_b32 v24, v32, v33, v34
    v_or_b32 v24, v24, v35
    v_and_b32 v24, v4, v24
    v_cmp_ne_u32 vcc, 0, v24
    s_cbranch_vccnz L_poll_64
    v_permlane32_swap_b32 v32, v34
    v_permlane32_swap_b32 v33, v35
    v_pk_add_f32 v[32:33], v[32:33], v[34:35]
    v_cvt_pk_bf16_f32 v32, v32, v33
    ds_write_b32 v9, v32 offset:4736
    s_bitcmp1_b32 s35, 0
    s_cbranch_scc1 L_must_66
    s_mov_b32 s7, 4194304
L_spin_67:
    ds_read_b32 v24, v5 offset:0
    s_sub_u32 s7, s7, 1
    s_cbranch_scc1 L_end
    s_waitcnt lgkmcnt(0)
    v_cmp_gt_u32 vcc, 0xb2, v24
    s_cbranch_vccnz L_spin_67
    ds_read_b64_tr_b16 v[40:41], v14 offset:0
    ds_read_b64_tr_b16 v[42:43], v14 offset:16384
    ds_read_b64_tr_b16 v[44:45], v14 offset:2048
    ds_read_b64_tr_b16 v[46:47], v14 offset:18432
    ds_read_b64_tr_b16 v[48:49], v14 offset:4096
    ds_read_b64_tr_b16 v[50:51], v14 offset:20480
    ds_read_b64_tr_b16 v[52:53], v14 offset:6144
    ds_read_b64_tr_b16 v[54:55], v14 offset:22528
    ds_read_b64_tr_b16 v[56:57], v14 offset:8192
    ds_read_b64_tr_b16 v[58:59], v14 offset:24576
    ds_read_b64_tr_b16 v[60:61], v14 offset:10240
    ds_read_b64_tr_b16 v[62:63], v14 offset:26624
    ds_read_b64_tr_b16 v[64:65], v14 offset:12288
    ds_read_b64_tr_b16 v[66:67], v14 offset:28672
    ds_read_b64_tr_b16 v[68:69], v14 offset:14336
    ds_read_b64_tr_b16 v[70:71], v14 offset:30720
L_must_66:
    s_waitcnt lgkmcnt(0)
    s_barrier
    s_cmp_ge_u32 s3, 4
    s_cbranch_scc1 L_fin
    ds_read_b128 v[104:107], v10 offset:4736
    ds_read_b128 v[108:111], v10 offset:4992
    ds_read_b128 v[112:115], v10 offset:5248
    ds_read_b128 v[116:119], v10 offset:5504
    ds_read_b128 v[120:123], v10 offset:5760
    ds_read_b128 v[124:127], v10 offset:6016
    ds_read_b128 v[128:131], v10 offset:6272
    ds_read_b128 v[132:135], v10 offset:6528
    s_waitcnt lgkmcnt(7)
    v_mfma_f32_16x16x32_bf16 v[32:35], v[40:43], v[104:107], 0
    s_waitcnt lgkmcnt(6)
    v_mfma_f32_16x16x32_bf16 v[32:35], v[44:47], v[108:111], v[32:35]
    s_waitcnt lgkmcnt(5)
    v_mfma_f32_16x16x32_bf16 v[32:35], v[48:51], v[112:115], v[32:35]
    s_waitcnt lgkmcnt(4)
    v_mfma_f32_16x16x32_bf16 v[32:35], v[52:55], v[116:119], v[32:35]
    s_waitcnt lgkmcnt(3)
    v_mfma_f32_16x16x32_bf16 v[32:35], v[56:59], v[120:123], v[32:35]
    s_waitcnt lgkmcnt(2)
    v_mfma_f32_16x16x32_bf16 v[32:35], v[60:63], v[124:127], v[32:35]
    s_waitcnt lgkmcnt(1)
    v_mfma_f32_16x16x32_bf16 v[32:35], v[64:67], v[128:131], v[32:35]
    s_waitcnt lgkmcnt(0)
    v_mfma_f32_16x16x32_bf16 v[32:35], v[68:71], v[132:135], v[32:35]
    s_nop 7
    v_cndmask_b32 v32, v32, v33, s[14:15]
    v_cndmask_b32 v34, v34, v35, s[14:15]
    v_cndmask_b32 v32, v32, v34, s[16:17]
    v_bfi_b32 v32, v4, v21, v32
    buffer_store_dword v32, v20, s[36:39], s12 offen sc1
    s_cmp_lg_u32 s42, 1
    s_cbranch_scc1 L_slow_68
    buffer_store_dword v32, v11, s[36:39], s13 offen
    s_branch L_pubd_69
L_slow_68:
    buffer_store_dword v32, v11, s[36:39], s13 offen sc1
L_pubd_69:
L_fin:
L_end:
    s_endpgm
.section .rodata,"a"
.p2align 6
.amdhsa_kernel sequential_preLN__sliding_block_cached__mixer_channel_mlp__decode_kernel
  .amdhsa_next_free_vgpr 168
  .amdhsa_next_free_sgpr 102
  .amdhsa_accum_offset 168
  .amdhsa_group_segment_fixed_size 0
  .amdhsa_kernarg_size 104
  .amdhsa_user_sgpr_count 2
  .amdhsa_user_sgpr_kernarg_segment_ptr 1
  .amdhsa_system_sgpr_workgroup_id_x 1
.end_amdhsa_kernel
```
